```python
import torch

def _softmax(x, axis=-1):
    return torch.softmax(x, dim=axis)

def _gelu(x):
    return torch.nn.functional.gelu(x, approximate='tanh')

def _silu(x):
    return torch.nn.functional.silu(x)

def _sigmoid(x):
    return torch.sigmoid(x)

def _layernorm(x, axis=-1, eps=1e-05):
    m = x.mean(dim=axis, keepdim=True)
    v = x.var(dim=axis, keepdim=True, unbiased=False)
    return (x - m) / torch.sqrt(v + eps)

def _scatter_add(tgt, idx, src, axis=0):
    return tgt.clone().index_add_(axis, idx, src)

def _segment_sum(src, seg, n):
    out = torch.zeros((n,) + src.shape[1:], dtype=src.dtype)
    return out.index_add_(0, seg, src)

def _pad(x, pw):
    flat = tuple((v for pair in reversed(pw) for v in pair))
    return torch.nn.functional.pad(x, flat)
kernel_name = 'adaLN_cond__ssm_conv_s4d__dense_activation_relu__prompt'

def setup_inputs():

    _w = lambda a: (lambda t: t.to(torch.bfloat16) if t.is_floating_point() else t)(torch.as_tensor(a))

    def _A_setup():
        Bsz, L, D, N = (1, 2048, 512, 128)
        return {'u': _w((lambda *s: torch.randn(*s, dtype=torch.bfloat16) * 0.05)(Bsz, L, D)), 'log_A_real': _w((lambda *s: torch.randn(*s, dtype=torch.bfloat16) * 3.2)(D, N) * 0.5), 'A_imag': _w((lambda *s: torch.randn(*s, dtype=torch.bfloat16) * 0.1)(D, N) * 3.14), 'C_real': _w((lambda *s: torch.randn(*s, dtype=torch.bfloat16) * 0.4)(D, N) / N ** 0.5), 'C_imag': _w((lambda *s: torch.randn(*s, dtype=torch.bfloat16) * 0.4)(D, N) / N ** 0.5), 'log_dt': _w((lambda *s: torch.randn(*s, dtype=torch.bfloat16) * 0.1)(D) * 0.5 - 4.0), 'D_skip': _w((lambda *s: torch.randn(*s, dtype=torch.bfloat16) * 0.1)(D))}
    _A_in = _A_setup()

    def _B_setup():
        B, S, D, Dff = (1, 2048, 512, 1376)
        return {'x': _w((lambda *s: torch.randn(*s, dtype=torch.bfloat16) * 0.05)(B, S, D)), 'w1': _w((lambda *s: torch.randn(*s, dtype=torch.bfloat16) * 0.05)(D, Dff)), 'w2': _w((lambda *s: torch.randn(*s, dtype=torch.bfloat16) * 0.05)(Dff, D))}
    _B_in = _B_setup()
    return {'A_u': _A_in['u'], 'A_log_A_real': _A_in['log_A_real'], 'A_A_imag': _A_in['A_imag'], 'A_C_real': _A_in['C_real'], 'A_C_imag': _A_in['C_imag'], 'A_log_dt': _A_in['log_dt'], 'A_D_skip': _A_in['D_skip'], 'B_x': _B_in['x'], 'B_w1': _B_in['w1'], 'B_w2': _B_in['w2'], 'c': _w((lambda *s: torch.randn(*s, dtype=torch.bfloat16) * 0.2)(1, 512) * 8.0), 'w_mod': _w((lambda *s: torch.randn(*s, dtype=torch.bfloat16) * 0.2)(512, 6 * 512) * 512 ** (-0.5) * 8.0)}

def reference(A_u, A_log_A_real, A_A_imag, A_C_real, A_C_imag, A_log_dt, A_D_skip, B_x, B_w1, B_w2, c, w_mod):

    def _A_ref(u, log_A_real, A_imag, C_real, C_imag, log_dt, D_skip):
        L = u.shape[1]
        dt = torch.exp(log_dt)
        A = -torch.exp(log_A_real) + 1j * A_imag
        C = (C_real + 1j * C_imag) * dt[:, None]
        pos = (lambda x, dt: x.to(dt))(torch.arange(L), log_dt.dtype)
        P = torch.exp((A * dt[:, None])[:, :, None] * pos[None, None, :])
        K = 2.0 * torch.einsum('dn,dnl->dl', C, P).real
        L2 = 2 * L
        u_t = (lambda x, *d: x.permute(*d))(u, 0, 2, 1)
        Kf = (lambda x, *a, **k: torch.fft.rfft(x.float(), *a, **k))(K, L2)
        Uf = (lambda x, *a, **k: torch.fft.rfft(x.float(), *a, **k))(u_t, L2)
        y = (lambda x, *a, **k: torch.fft.irfft(x, *a, **k).to(torch.bfloat16))(Uf * Kf[None, :, :], L2)[:, :, :L]
        y = (lambda x, *d: x.permute(*d))(y, 0, 2, 1)
        return y + u * D_skip[None, None, :]

    def _B_ref(x, w1, w2):
        h = torch.einsum('bsd,df->bsf', x, w1)
        zero = torch.zeros_like(h)
        h = torch.maximum(h, zero)
        return torch.einsum('bsf,fd->bsd', h, w2)
    x = A_u
    mod = (_silu(c) @ w_mod).reshape(c.shape[0], 6, 1, -1)
    sa, ca, ga, sb, cb, gb = (mod[:, 0].clone(), mod[:, 1].clone(), mod[:, 2].clone(), mod[:, 3].clone(), mod[:, 4].clone(), mod[:, 5].clone())
    h = _layernorm(x, axis=-1) * (1 + ca) + sa
    x = x + ga * _A_ref(h, A_log_A_real, A_A_imag, A_C_real, A_C_imag, A_log_dt, A_D_skip)
    h = _layernorm(x, axis=-1) * (1 + cb) + sb
    x = x + gb * _B_ref(h, B_w1, B_w2)
    return x
```

```asm
; @launch grid=(256,1,1) block=(256,1,1) lds=136448
.amdgcn_target "amdgcn-amd-amdhsa--gfx950"
.text
.globl adaLN_cond__ssm_conv_s4d__dense_activation_relu__prompt_kernel
.p2align 8
.type adaLN_cond__ssm_conv_s4d__dense_activation_relu__prompt_kernel,@function
adaLN_cond__ssm_conv_s4d__dense_activation_relu__prompt_kernel:
    s_lshr_b32 s31, s2, 3
    s_cmp_ge_u32 s31, 32
    s_cbranch_scc1 L_end
    s_load_dwordx16 s[4:19], s[0:1], 0
    s_load_dwordx8 s[20:27], s[0:1], 64
    s_load_dwordx2 s[32:33], s[0:1], 112
    s_getpc_b64 s[46:47]
L_pc:
    s_lshl_b32 s44, s31, 10
    v_lshl_add_u32 v2, v0, 2, s44
    v_min_u32 v2, L_tabend-L_pc-4, v2
    global_load_dword v100, v2, s[46:47]
    v_lshrrev_b32 v16, 6, v0
    v_and_b32 v1, 63, v0
    s_and_b32 s30, s2, 7
    v_readfirstlane_b32 s3, v16
    v_lshlrev_b32 v3, 4, v1
    s_lshl_b32 s44, s30, 5
    s_add_u32 s40, s44, s31
    s_lshl_b32 s44, s40, 9
    v_lshl_add_u32 v46, v0, 1, s44
    s_lshl_b32 s44, s31, 5
    s_add_u32 s44, s44, s30
    s_lshl_b32 s44, s44, 11
    v_lshl_add_u32 v47, v16, 14, v3
    v_add_u32 v47, s44, v47
    s_lshl_b32 s44, s40, 2
    s_waitcnt lgkmcnt(0)
    s_load_dword s42, s[14:15], s44
    global_load_ushort v12, v46, s[6:7] nt
    global_load_ushort v13, v46, s[8:9] nt
    global_load_ushort v14, v46, s[10:11] nt
    global_load_ushort v15, v46, s[12:13] nt
    global_load_dwordx4 v[4:7], v47, s[4:5] nt
    global_load_dwordx4 v[8:11], v47, s[4:5] offset:1024 nt
    s_load_dword s41, s[32:33], 0
    s_load_dword s43, s[16:17], s44
    s_load_dwordx2 s[28:29], s[0:1], 96
    s_mul_i32 s45, s3, 10240
    s_add_u32 s45, s45, 91392
    s_mov_b32 m0, s45
    s_lshr_b32 s44, s31, 2
    s_mul_i32 s44, s44, 114688
    s_lshr_b32 s64, s3, 1
    s_mul_i32 s64, s64, 1044480
    s_add_u32 s44, s44, s64
    s_lshl1_add_u32 s64, s31, s3
    s_lshl4_add_u32 s64, s64, s30
    s_lshl_b32 s64, s64, 7
    s_add_u32 s44, s44, s64
    v_lshrrev_b32 v17, 3, v1
    v_xor_b32 v120, v1, v17
    v_and_b32 v120, 7, v120
    v_lshl_add_u32 v120, v120, 4, s44
    v_lshl_add_u32 v120, v17, 14, v120
    global_load_lds_dwordx4 v120, s[4:5] nt
    global_load_lds_dwordx4 v120, s[4:5] offset:1024 nt
    s_mul_i32 s66, s40, 3
    s_add_u32 s66, s66, s3
    s_cmp_eq_u32 s3, 3
    s_cselect_b32 s66, 1000, s66
    s_mul_i32 s67, s66, 1525
    s_lshr_b32 s67, s67, 16
    s_mul_i32 s64, s67, 85312
    s_lshl_b32 s65, s66, 6
    s_add_u32 s64, s64, s65
    s_add_u32 m0, s45, 2048
    s_mov_b32 s36, s20
    s_mov_b32 s37, s21
    s_mov_b32 s38, 1409024
    s_mov_b32 s39, 0x20000
    v_lshrrev_b32 v122, 2, v1
    v_and_b32 v121, 48, v3
    s_movk_i32 s65, 2752
    v_mad_u32_u24 v123, v122, s65, v121
    buffer_load_dwordx4 v123, s[36:39], s64 offen nt lds
    s_add_u32 s64, s64, 43008
    buffer_load_dwordx4 v123, s[36:39], s64 offen offset:1024 nt lds
    s_and_b32 s64, s31, 3
    s_lshl_b32 s65, s64, 8
    v_and_b32 v124, 127, v0
    v_lshl_add_u32 v125, v124, 1, s65
    global_load_ushort v19, v125, s[24:25]
    s_lshl2_add_u32 s64, s64, s3
    s_mul_i32 s64, s64, 196608
    s_lshr_b32 s65, s31, 2
    s_lshl3_add_u32 s65, s65, s30
    s_lshl_b32 s65, s65, 7
    s_add_u32 s64, s64, s65
    s_cmp_lt_u32 s31, 24
    s_cselect_b32 s64, s64, 150994944
    s_mov_b32 s36, s26
    s_mov_b32 s37, s27
    s_mov_b32 s38, 3145728
    s_add_u32 m0, s45, 6144
    v_and_b32 v123, 6, v17
    v_xor_b32 v123, v123, v1
    v_and_b32 v123, 7, v123
    v_lshlrev_b32 v123, 4, v123
    s_movk_i32 s65, 6144
    v_mad_u32_u24 v123, v17, s65, v123
    s_mov_b32 s19, s64
    s_add_u32 s18, s45, 4096
    buffer_load_dwordx4 v123, s[36:39], s19 offen offset:0 nt lds
    s_add_u32 s19, s19, 48128
    buffer_load_dwordx4 v123, s[36:39], s19 offen offset:1024 nt lds
    s_add_u32 s19, s19, 48128
    buffer_load_dwordx4 v123, s[36:39], s19 offen offset:2048 nt lds
    s_add_u32 s19, s19, 48128
    buffer_load_dwordx4 v123, s[36:39], s19 offen offset:3072 nt lds
    v_and_b32 v18, 31, v0
    v_and_b32 v16, 64, v0
    v_lshl_add_u32 v18, v18, 1, v16
    v_add_u32 v18, L_tab-L_pc, v18
    s_lshr_b32 s68, s66, 4
    s_and_b32 s69, s66, 15
    s_lshl_b32 s64, s68, 15
    s_lshl_b32 s65, s69, 6
    s_add_u32 s2, s64, s65
    v_lshl_add_u32 v122, v122, 10, v121
    s_mov_b32 s34, 0x9000000
    s_mov_b32 s35, 0x20000
    v_and_b32 v16, 0x70, v3
    s_movk_i32 s49, 4096
    s_movk_i32 s50, 8192
    s_movk_i32 s51, 12288
    s_movk_i32 s52, 16384
    s_movk_i32 s53, 20480
    s_movk_i32 s54, 24576
    s_movk_i32 s55, 28672
    s_mov_b32 s56, 32768
    s_mov_b32 s57, 36864
    s_mov_b32 s58, 40960
    s_mov_b32 s48, 100000
    s_mul_i32 s20, s67, 4293559296
    s_lshl_b32 s64, s66, 15
    s_add_u32 s20, s20, s64
    s_add_u32 s20, s20, 1048576
    s_lshr_b32 s64, s69, 1
    s_mul_i32 s64, s64, 43
    s_add_u32 s64, s64, s68
    s_and_b32 s65, s69, 1
    s_lshl1_add_u32 s64, s64, s65
    s_lshl_b32 s64, s64, 11
    s_add_u32 s21, s64, 2621440
    s_mul_i32 s27, s67, 4294945312
    s_lshl_b32 s64, s66, 9
    s_add_u32 s27, s27, s64
    s_add_u32 s27, s27, 196608
    s_cmp_lt_u32 s66, 688
    s_cselect_b32 s20, s20, 150994944
    s_cselect_b32 s21, s21, 150994944
    s_cselect_b32 s27, s27, 150994944
    s_getreg_b32 s63, hwreg(HW_REG_XCC_ID, 0, 4)
    s_xor_b32 s63, s63, s30
    s_lshr_b32 s64, s31, 4
    s_and_b32 s65, s30, 1
    s_lshl1_add_u32 s64, s64, s65
    s_bfe_u32 s65, s31, 0x20002
    s_lshl2_add_u32 s64, s64, s65
    s_lshr_b32 s65, s30, 1
    s_lshl2_add_u32 s64, s64, s65
    s_and_b32 s65, s31, 3
    s_lshl2_add_u32 s64, s64, s65
    s_lshl2_add_u32 s64, s64, s3
    s_lshl4_add_u32 s1, s64, s49
    v_mov_b32 v76, 0
    v_mov_b32 v77, 0
    v_mov_b32 v78, 0
    v_mov_b32 v79, 0
    v_lshrrev_b32 v80, 4, v1
    v_and_b32 v81, 15, v1
    v_mul_u32_u24 v82, 2304, v80
    v_lshl_add_u32 v82, v81, 4, v82
    v_add_u32 v82, 82176, v82
    v_mul_u32_u24 v83, 4160, v80
    v_and_b32 v84, 1, v1
    v_lshl_add_u32 v83, v84, 4, v83
    v_add_u32 v83, 69632, v83
    ds_write_b128 v82, v[76:79]
    ds_write_b128 v83, v[76:79]
    v_and_b32 v82, 16, v1
    v_and_b32 v83, 32, v1
    v_lshl_add_u32 v46, v81, 4, s45
    v_lshl_add_u32 v46, v82, 5, v46
    v_lshl_add_u32 v46, v83, 3, v46
    v_bfe_u32 v47, v1, 3, 2
    v_xor_b32 v47, s3, v47
    v_lshlrev_b32 v47, 5, v47
    v_lshl_add_u32 v47, v83, 6, v47
    v_and_b32 v85, 28, v1
    v_lshl_add_u32 v47, v85, 5, v47
    v_and_b32 v85, 3, v1
    v_lshl_add_u32 v47, v85, 3, v47
    v_add_u32 v47, 97536, v47
    v_and_b32 v85, 7, v1
    v_lshrrev_b32 v86, 5, v1
    v_lshl_add_u32 v86, s3, 1, v86
    v_xor_b32 v86, v86, v85
    v_lshlrev_b32 v86, 4, v86
    v_lshl_add_u32 v86, v85, 7, v86
    v_and_b32 v85, 3, v17
    v_lshl_add_u32 v86, v85, 2, v86
    v_add_u32 v120, 91392, v86
    v_lshrrev_b32 v85, 1, v124
    v_xor_b32 v85, v85, v124
    v_bfe_u32 v85, v85, 2, 1
    v_mul_u32_u24 v85, 12, v85
    v_xor_b32 v124, v124, v85
    v_lshlrev_b32 v124, 1, v124
    v_add_u32 v124, 135424, v124
    s_lshl2_add_u32 s64, s30, s3
    s_mul_i32 s64, s64, 98304
    s_and_b32 s65, s31, 3
    s_bfe_u32 s44, s31, 0x10002
    s_lshl1_add_u32 s65, s65, s44
    s_and_b32 s44, s31, 24
    s_add_u32 s65, s65, s44
    s_lshl_b32 s65, s65, 7
    s_add_u32 s64, s64, s65
    s_add_u32 s64, s64, 14680064
    v_and_b32 v16, 0x70, v3
    v_mul_u32_u24 v99, 12288, v17
    v_add3_u32 v99, v99, v16, s64
    v_lshl_add_u32 v126, v80, 1, v84
    v_lshlrev_b32 v126, 4, v126
    v_lshlrev_b32 v127, 4, v80
    v_add_u32 v127, 135424, v127
    s_mul_i32 s24, s30, 12288
    s_add_u32 s24, s24, 65536
    s_lshl2_add_u32 s64, s31, s3
    s_lshl_b32 s64, s64, 7
    s_add_u32 s25, s24, s64
    s_cmp_lt_u32 s31, 24
    s_cselect_b32 s25, s25, 150994944
    s_lshl4_add_u32 s24, s31, s24
    s_waitcnt lgkmcnt(0)
    s_mul_i32 s41, s41, 0x9e3779b5
    s_add_u32 s41, s41, 0x7f4a7c15
    s_lshl_b32 s44, s42, 16
    s_and_b32 s45, s42, 0xffff0000
    s_cmp_lt_u32 s3, 2
    s_cselect_b32 s44, s44, s45
    s_lshl_b32 s64, s43, 16
    s_and_b32 s45, s43, 0xffff0000
    s_cmp_lt_u32 s3, 2
    s_cselect_b32 s43, s64, s45
    v_mov_b32 v16, 0x3fb8aa3b
    v_mul_f32 v17, s44, v16
    v_mov_b32 v95, s41
    v_exp_f32 v17, v17
    v_mov_b32 v51, s41
    v_mov_b32 v55, s41
    v_mov_b32 v58, s41
    v_mov_b32 v59, s41
    s_lshr_b32 s44, s3, 1
    s_mul_i32 s44, s44, 31680
    s_and_b32 s45, s3, 1
    s_lshl_b32 s64, s45, 8
    s_add_u32 m0, s44, s64
    s_mov_b32 s64, 0x3f803f80
    s_mov_b32 s65, 0x3b000000
    s_waitcnt vmcnt(11)
    v_lshlrev_b32 v12, 16, v12
    v_lshlrev_b32 v13, 16, v13
    v_lshlrev_b32 v14, 16, v14
    v_lshlrev_b32 v15, 16, v15
    v_mul_f32 v12, v16, v12
    v_exp_f32 v12, v12
    s_nop 0
    v_cvt_pk_bf16_f32 v17, v17, v12
    v_and_b32 v12, 0xffff0000, v17
    v_lshlrev_b32 v17, 16, v17
    v_mul_f32 v12, v12, v17
    v_mul_f32 v13, v13, v17
    v_add_f32 v17, v17, v17
    v_mul_f32 v12, 0xbfb8aa3b, v12
    v_mul_f32 v13, 0.15915494, v13
    v_mul_f32 v28, v14, v17
    v_mul_f32 v29, v15, -v17
    v_mul_f32 v104, 1.0, v12
    v_mul_f32 v106, 0x41000000, v12
    v_mul_f32 v108, 0x41800000, v12
    v_mul_f32 v110, 0x43800000, v12
    v_mul_f32 v105, 1.0, v13
    v_mul_f32 v107, 0x41000000, v13
    v_mul_f32 v109, 0x41800000, v13
    v_mul_f32 v111, 0x43800000, v13
    v_exp_f32 v104, v104
    v_exp_f32 v106, v106
    v_exp_f32 v108, v108
    v_exp_f32 v110, v110
    v_fract_f32 v105, v105
    v_fract_f32 v107, v107
    v_fract_f32 v109, v109
    v_fract_f32 v111, v111
    v_cos_f32 v20, v105
    v_cos_f32 v22, v107
    v_cos_f32 v24, v109
    v_cos_f32 v26, v111
    v_sin_f32 v21, v105
    v_sin_f32 v23, v107
    v_sin_f32 v25, v109
    v_sin_f32 v27, v111
    v_mul_f32 v20, v20, v104
    v_mul_f32 v22, v22, v106
    v_mul_f32 v24, v24, v108
    v_mul_f32 v26, v26, v110
    v_mul_f32 v21, v21, -v104
    v_mul_f32 v23, v23, v106
    v_mul_f32 v25, v25, v108
    v_mul_f32 v27, v27, -v110
    s_waitcnt vmcnt(9)
    s_mov_b32 s0, m0
    s_mov_b32 m0, s18
    s_mov_b32 s36, s22
    s_mov_b32 s37, s23
    s_mov_b32 s38, 1409024
    buffer_load_dwordx4 v122, s[36:39], s2 offen nt lds
    s_add_u32 s2, s2, 15360
    buffer_load_dwordx4 v122, s[36:39], s2 offen offset:1024 nt lds
    global_load_ushort v18, v18, s[46:47]
    s_mov_b32 m0, s0
    v_dot2_f32_bf16 v88, v4, s64, 0
    v_dot2_f32_bf16 v89, v4, v4, 0
    v_dot2_f32_bf16 v90, v8, s64, 0
    v_dot2_f32_bf16 v91, v8, v8, 0
    v_dot2_f32_bf16 v88, v5, s64, v88
    v_dot2_f32_bf16 v89, v5, v5, v89
    v_dot2_f32_bf16 v90, v9, s64, v90
    v_dot2_f32_bf16 v91, v9, v9, v91
    v_dot2_f32_bf16 v88, v6, s64, v88
    v_dot2_f32_bf16 v89, v6, v6, v89
    v_dot2_f32_bf16 v90, v10, s64, v90
    v_dot2_f32_bf16 v91, v10, v10, v91
    v_dot2_f32_bf16 v88, v7, s64, v88
    v_dot2_f32_bf16 v89, v7, v7, v89
    v_dot2_f32_bf16 v90, v11, s64, v90
    v_dot2_f32_bf16 v91, v11, v11, v91
    v_mov_b32 v112, 0x3f80
    v_cvt_pk_bf16_f32 v114, v22, v23
    v_permlane32_swap_b32 v88, v90
    v_permlane32_swap_b32 v89, v91
    v_add_f32 v88, v88, v90
    v_add_f32 v89, v89, v91
    v_pk_mul_f32 v[108:109], v[28:29], v[20:21] op_sel:[0,0] op_sel_hi:[0,1]
    v_cvt_pk_bf16_f32 v118, v28, v29
    v_permlane16_swap_b32 v88, v89
    v_add_f32 v88, v88, v89
    ds_write_addtid_b32 v112 offset:0
    ds_write_addtid_b32 v114 offset:528
    v_add_f32_dpp v88, v88, v88 row_ror:8 row_mask:0xf bank_mask:0xf
    v_pk_fma_f32 v[42:43], v[28:29], v[20:21], v[108:109] op_sel:[1,1,0] op_sel_hi:[1,0,1] neg_lo:[0,1,0]
    ds_write_addtid_b32 v118 offset:16896
    v_add_f32_dpp v88, v88, v88 row_ror:4 row_mask:0xf bank_mask:0xf
    v_cvt_pk_bf16_f32 v113, v24, v25
    v_pk_mul_f32 v[106:107], v[22:23], v[24:25] op_sel:[0,0] op_sel_hi:[0,1]
    v_add_f32_dpp v88, v88, v88 row_ror:2 row_mask:0xf bank_mask:0xf
    v_cvt_pk_bf16_f32 v117, v42, v43
    v_pk_mul_f32 v[110:111], v[28:29], v[26:27] op_sel:[0,0] op_sel_hi:[0,1]
    v_add_f32_dpp v88, v88, v88 row_ror:1 row_mask:0xf bank_mask:0xf
    v_mul_f32 v88, s65, v88
    v_mov_b32 v89, v88
    ds_write_addtid_b32 v113 offset:1056
    v_pk_fma_f32 v[32:33], v[22:23], v[24:25], v[106:107] op_sel:[1,1,0] op_sel_hi:[1,0,1] neg_lo:[0,1,0]
    v_permlane16_swap_b32 v88, v89
    v_fma_f32 v89, -v88, v88, v89
    v_max_f32 v89, 0, v89
    v_mov_b32 v90, v88
    v_cvt_pk_bf16_f32 v89, v89, v89
    v_lshlrev_b32 v89, 16, v89
    v_add_f32 v89, 0x3727c5ac, v89
    v_permlane32_swap_b32 v88, v90
    v_cvt_pk_bf16_f32 v89, v89, v89
    v_lshlrev_b32 v89, 16, v89
    v_sqrt_f32 v89, v89
    v_cvt_pk_bf16_f32 v94, v88, v90
    v_cvt_pk_bf16_f32 v89, v89, v89
    v_lshlrev_b32 v89, 16, v89
    v_rcp_f32 v92, v89
    v_rcp_f32 v93, v89
    ds_write_addtid_b32 v117 offset:17424
    v_pk_fma_f32 v[44:45], v[28:29], v[26:27], v[110:111] op_sel:[1,1,0] op_sel_hi:[1,0,1] neg_lo:[0,1,0]
    v_permlane32_swap_b32 v92, v93
    s_mov_b64 exec, 1
    buffer_store_dwordx4 v[92:95], v76, s[32:35], s1 offen sc1
    s_mov_b64 exec, -1
    s_waitcnt vmcnt(11)
    s_barrier
    ds_read2st64_b32 v[48:49], v120 offset0:0 offset1:4
    ds_read_b32 v50, v120 offset:10240
    ds_read2st64_b32 v[52:53], v120 offset0:44 offset1:80
    ds_read_b32 v54, v120 offset:21504
    ds_read2st64_b32 v[56:57], v120 offset0:120 offset1:124
    v_pk_mul_f32 v[104:105], v[24:25], v[24:25] op_sel:[0,0] op_sel_hi:[0,1]
    v_cvt_pk_bf16_f32 v115, v32, v33
    v_pk_mul_f32 v[108:109], v[42:43], v[20:21] op_sel:[0,0] op_sel_hi:[0,1]
    v_cvt_pk_bf16_f32 v119, v44, v45
    v_pk_fma_f32 v[30:31], v[24:25], v[24:25], v[104:105] op_sel:[1,1,0] op_sel_hi:[1,0,1] neg_lo:[0,1,0]
    ds_write_addtid_b32 v115 offset:1584
    v_pk_fma_f32 v[34:35], v[42:43], v[20:21], v[108:109] op_sel:[1,1,0] op_sel_hi:[1,0,1] neg_lo:[0,1,0]
    ds_write_addtid_b32 v119 offset:21648
    s_waitcnt lgkmcnt(2)
    s_cmp_lg_u32 s63, 0
    s_cbranch_scc1 L_far_1
    buffer_store_dwordx4 v[48:51], v99, s[32:35], 0 offen
    buffer_store_dwordx4 v[52:55], v99, s[32:35], s49 offen
    buffer_store_dwordx4 v[56:59], v99, s[32:35], s50 offen
L_near_2:
    s_waitcnt vmcnt(12)
    ds_read_b64_tr_b16 v[60:61], v46 offset:2048
    ds_read_b64_tr_b16 v[62:63], v46 offset:3072
    ds_read_b64_tr_b16 v[64:65], v46 offset:2056
    ds_read_b64_tr_b16 v[66:67], v46 offset:3080
    v_cvt_pk_bf16_f32 v112, v30, v31
    v_pk_mul_f32 v[106:107], v[32:33], v[24:25] op_sel:[0,0] op_sel_hi:[0,1]
    v_cvt_pk_bf16_f32 v116, v34, v35
    v_pk_mul_f32 v[110:111], v[44:45], v[26:27] op_sel:[0,0] op_sel_hi:[0,1]
    ds_write_addtid_b32 v112 offset:2112
    v_pk_fma_f32 v[32:33], v[32:33], v[24:25], v[106:107] op_sel:[1,1,0] op_sel_hi:[1,0,1] neg_lo:[0,1,0]
    ds_write_addtid_b32 v116 offset:17952
    v_pk_fma_f32 v[44:45], v[44:45], v[26:27], v[110:111] op_sel:[1,1,0] op_sel_hi:[1,0,1] neg_lo:[0,1,0]
    v_pk_mul_f32 v[104:105], v[30:31], v[24:25] op_sel:[0,0] op_sel_hi:[0,1]
    v_cvt_pk_bf16_f32 v114, v32, v33
    s_waitcnt lgkmcnt(2)
    buffer_store_dwordx4 v[60:63], v3, s[32:35], s20 offen sc1
    s_add_u32 s20, s20, 16384
    buffer_store_dwordx4 v[64:67], v3, s[32:35], s20 offen sc1
    v_pk_mul_f32 v[108:109], v[34:35], v[20:21] op_sel:[0,0] op_sel_hi:[0,1]
    v_cvt_pk_bf16_f32 v118, v44, v45
    s_waitcnt vmcnt(13)
    v_lshlrev_b32 v19, 16, v19
    v_mul_f32 v88, 0xbfb8aa3b, v19
    v_exp_f32 v88, v88
    v_pk_fma_f32 v[30:31], v[30:31], v[24:25], v[104:105] op_sel:[1,1,0] op_sel_hi:[1,0,1] neg_lo:[0,1,0]
    v_add_f32 v88, 1.0, v88
    v_rcp_f32 v88, v88
    ds_write_addtid_b32 v114 offset:2640
    v_mul_f32 v88, v88, v19
    v_cvt_pk_bf16_f32 v88, v88, v88
    ds_write_b16 v124, v88
    v_pk_fma_f32 v[42:43], v[34:35], v[20:21], v[108:109] op_sel:[1,1,0] op_sel_hi:[1,0,1] neg_lo:[0,1,0]
    ds_write_addtid_b32 v118 offset:24288
    v_cvt_pk_bf16_f32 v113, v30, v31
    v_pk_mul_f32 v[106:107], v[32:33], v[24:25] op_sel:[0,0] op_sel_hi:[0,1]
    v_cvt_pk_bf16_f32 v117, v42, v43
    v_pk_mul_f32 v[110:111], v[44:45], v[26:27] op_sel:[0,0] op_sel_hi:[0,1]
    ds_write_addtid_b32 v113 offset:3168
    v_pk_fma_f32 v[32:33], v[32:33], v[24:25], v[106:107] op_sel:[1,1,0] op_sel_hi:[1,0,1] neg_lo:[0,1,0]
    ds_write_addtid_b32 v117 offset:18480
    v_pk_fma_f32 v[44:45], v[44:45], v[26:27], v[110:111] op_sel:[1,1,0] op_sel_hi:[1,0,1] neg_lo:[0,1,0]
    v_pk_mul_f32 v[104:105], v[30:31], v[24:25] op_sel:[0,0] op_sel_hi:[0,1]
    v_cvt_pk_bf16_f32 v115, v32, v33
    v_pk_mul_f32 v[108:109], v[42:43], v[20:21] op_sel:[0,0] op_sel_hi:[0,1]
    v_cvt_pk_bf16_f32 v119, v44, v45
    v_pk_fma_f32 v[30:31], v[30:31], v[24:25], v[104:105] op_sel:[1,1,0] op_sel_hi:[1,0,1] neg_lo:[0,1,0]
    ds_write_addtid_b32 v115 offset:3696
    v_pk_fma_f32 v[36:37], v[42:43], v[20:21], v[108:109] op_sel:[1,1,0] op_sel_hi:[1,0,1] neg_lo:[0,1,0]
    ds_write_addtid_b32 v119 offset:25872
    v_cvt_pk_bf16_f32 v112, v30, v31
    v_pk_mul_f32 v[106:107], v[32:33], v[24:25] op_sel:[0,0] op_sel_hi:[0,1]
    v_cvt_pk_bf16_f32 v116, v36, v37
    v_pk_mul_f32 v[110:111], v[44:45], v[26:27] op_sel:[0,0] op_sel_hi:[0,1]
    ds_write_addtid_b32 v112 offset:4224
    v_pk_fma_f32 v[32:33], v[32:33], v[24:25], v[106:107] op_sel:[1,1,0] op_sel_hi:[1,0,1] neg_lo:[0,1,0]
    ds_write_addtid_b32 v116 offset:19008
    v_pk_fma_f32 v[44:45], v[44:45], v[26:27], v[110:111] op_sel:[1,1,0] op_sel_hi:[1,0,1] neg_lo:[0,1,0]
    v_pk_mul_f32 v[104:105], v[30:31], v[24:25] op_sel:[0,0] op_sel_hi:[0,1]
    v_cvt_pk_bf16_f32 v114, v32, v33
    s_waitcnt vmcnt(9)
    s_waitcnt lgkmcnt(7)
    s_barrier
    ds_read_b64_tr_b16 v[128:129], v47 offset:0
    ds_read_b64_tr_b16 v[130:131], v47 offset:1024
    ds_read_b128 v[144:147], v127 offset:0
    v_pk_mul_f32 v[108:109], v[36:37], v[20:21] op_sel:[0,0] op_sel_hi:[0,1]
    ds_read_b64_tr_b16 v[132:133], v47 offset:10240
    ds_read_b64_tr_b16 v[134:135], v47 offset:11264
    ds_read_b128 v[148:151], v127 offset:64
    v_cvt_pk_bf16_f32 v118, v44, v45
    ds_read_b64_tr_b16 v[136:137], v47 offset:20480
    ds_read_b64_tr_b16 v[138:139], v47 offset:21504
    ds_read_b128 v[152:155], v127 offset:128
    v_pk_fma_f32 v[30:31], v[30:31], v[24:25], v[104:105] op_sel:[1,1,0] op_sel_hi:[1,0,1] neg_lo:[0,1,0]
    ds_read_b64_tr_b16 v[140:141], v47 offset:30720
    ds_read_b64_tr_b16 v[142:143], v47 offset:31744
    ds_read_b128 v[156:159], v127 offset:192
    ds_write_addtid_b32 v114 offset:4752
    v_pk_fma_f32 v[42:43], v[36:37], v[20:21], v[108:109] op_sel:[1,1,0] op_sel_hi:[1,0,1] neg_lo:[0,1,0]
    ds_write_addtid_b32 v118 offset:27456
    v_cvt_pk_bf16_f32 v113, v30, v31
    v_pk_mul_f32 v[106:107], v[32:33], v[24:25] op_sel:[0,0] op_sel_hi:[0,1]
    v_cvt_pk_bf16_f32 v117, v42, v43
    v_pk_mul_f32 v[110:111], v[44:45], v[26:27] op_sel:[0,0] op_sel_hi:[0,1]
    ds_write_addtid_b32 v113 offset:5280
    v_pk_fma_f32 v[32:33], v[32:33], v[24:25], v[106:107] op_sel:[1,1,0] op_sel_hi:[1,0,1] neg_lo:[0,1,0]
    s_waitcnt lgkmcnt(12)
    v_mfma_f32_16x16x32_bf16 v[68:71], v[128:131], v[144:147], 0
    ds_write_addtid_b32 v117 offset:19536
    v_pk_fma_f32 v[44:45], v[44:45], v[26:27], v[110:111] op_sel:[1,1,0] op_sel_hi:[1,0,1] neg_lo:[0,1,0]
    v_pk_mul_f32 v[104:105], v[30:31], v[24:25] op_sel:[0,0] op_sel_hi:[0,1]
    s_waitcnt lgkmcnt(10)
    v_mfma_f32_16x16x32_bf16 v[68:71], v[132:135], v[148:151], v[68:71]
    v_cvt_pk_bf16_f32 v115, v32, v33
    v_pk_mul_f32 v[108:109], v[42:43], v[20:21] op_sel:[0,0] op_sel_hi:[0,1]
    v_cvt_pk_bf16_f32 v119, v44, v45
    s_waitcnt lgkmcnt(7)
    v_mfma_f32_16x16x32_bf16 v[68:71], v[136:139], v[152:155], v[68:71]
    v_pk_fma_f32 v[30:31], v[30:31], v[24:25], v[104:105] op_sel:[1,1,0] op_sel_hi:[1,0,1] neg_lo:[0,1,0]
    ds_write_addtid_b32 v115 offset:5808
    v_pk_fma_f32 v[38:39], v[42:43], v[20:21], v[108:109] op_sel:[1,1,0] op_sel_hi:[1,0,1] neg_lo:[0,1,0]
    s_waitcnt lgkmcnt(5)
    v_mfma_f32_16x16x32_bf16 v[68:71], v[140:143], v[156:159], v[68:71]
    ds_write_addtid_b32 v119 offset:28512
    v_cvt_pk_bf16_f32 v112, v30, v31
    v_pk_mul_f32 v[106:107], v[32:33], v[24:25] op_sel:[0,0] op_sel_hi:[0,1]
    v_cvt_pk_bf16_f32 v116, v38, v39
    v_pk_mul_f32 v[110:111], v[44:45], v[26:27] op_sel:[0,0] op_sel_hi:[0,1]
    ds_write_addtid_b32 v112 offset:6336
    v_pk_fma_f32 v[32:33], v[32:33], v[24:25], v[106:107] op_sel:[1,1,0] op_sel_hi:[1,0,1] neg_lo:[0,1,0]
    ds_write_addtid_b32 v116 offset:20064
    s_mov_b32 vcc_lo, 0xaaaaaaaa
    s_mov_b32 vcc_hi, 0xaaaaaaaa
    v_cndmask_b32 v56, v68, v70, vcc
    v_cndmask_b32 v57, v69, v71, vcc
    s_mov_b32 exec_lo, 0x00030003
    s_mov_b32 exec_hi, 0x00030003
    buffer_store_dwordx4 v[56:59], v126, s[32:35], s25 offen sc1
    s_mov_b64 exec, -1
    v_pk_fma_f32 v[44:45], v[44:45], v[26:27], v[110:111] op_sel:[1,1,0] op_sel_hi:[1,0,1] neg_lo:[0,1,0]
    v_pk_mul_f32 v[104:105], v[30:31], v[24:25] op_sel:[0,0] op_sel_hi:[0,1]
    v_cvt_pk_bf16_f32 v114, v32, v33
    v_pk_mul_f32 v[108:109], v[38:39], v[20:21] op_sel:[0,0] op_sel_hi:[0,1]
    v_cvt_pk_bf16_f32 v118, v44, v45
    v_pk_fma_f32 v[30:31], v[30:31], v[24:25], v[104:105] op_sel:[1,1,0] op_sel_hi:[1,0,1] neg_lo:[0,1,0]
    ds_write_addtid_b32 v114 offset:6864
    v_pk_fma_f32 v[42:43], v[38:39], v[20:21], v[108:109] op_sel:[1,1,0] op_sel_hi:[1,0,1] neg_lo:[0,1,0]
    ds_write_addtid_b32 v118 offset:29568
    v_cvt_pk_bf16_f32 v113, v30, v31
    v_pk_mul_f32 v[106:107], v[32:33], v[24:25] op_sel:[0,0] op_sel_hi:[0,1]
    v_cvt_pk_bf16_f32 v117, v42, v43
    v_pk_mul_f32 v[110:111], v[44:45], v[26:27] op_sel:[0,0] op_sel_hi:[0,1]
    ds_write_addtid_b32 v113 offset:7392
    v_pk_fma_f32 v[32:33], v[32:33], v[24:25], v[106:107] op_sel:[1,1,0] op_sel_hi:[1,0,1] neg_lo:[0,1,0]
    ds_write_addtid_b32 v117 offset:20592
    v_pk_fma_f32 v[44:45], v[44:45], v[26:27], v[110:111] op_sel:[1,1,0] op_sel_hi:[1,0,1] neg_lo:[0,1,0]
    v_pk_mul_f32 v[104:105], v[30:31], v[24:25] op_sel:[0,0] op_sel_hi:[0,1]
    v_cvt_pk_bf16_f32 v115, v32, v33
    v_pk_mul_f32 v[108:109], v[42:43], v[20:21] op_sel:[0,0] op_sel_hi:[0,1]
    v_cvt_pk_bf16_f32 v119, v44, v45
    s_mul_i32 s66, s40, 12288
    s_mul_i32 s67, s3, 3072
    s_add_u32 s66, s66, s67
    s_add_u32 s66, s66, 14680064
    v_lshl_add_u32 v14, v1, 7, s66
    s_and_b32 s66, s40, 7
    s_lshl2_add_u32 s66, s66, s3
    s_mul_i32 s66, s66, 6
    s_sub_u32 s66, s66, 24
    v_min_u32 v160, 29, v1
    v_add_u32 v160, s66, v160
    v_min_u32 v160, 175, v160
    s_lshr_b32 s66, s40, 3
    s_mul_i32 s66, s66, 22528
    s_add_u32 s66, s66, 11534336
    v_cmp_gt_u32 vcc, 24, v1
    v_lshl_add_u32 v160, v160, 7, s66
    s_nop 0
    v_cndmask_b32 v14, v160, v14, vcc
    buffer_load_dword v14, v14, s[32:35], 0 offen sc1
    v_pk_fma_f32 v[30:31], v[30:31], v[24:25], v[104:105] op_sel:[1,1,0] op_sel_hi:[1,0,1] neg_lo:[0,1,0]
    ds_write_addtid_b32 v115 offset:7920
    v_pk_fma_f32 v[40:41], v[42:43], v[20:21], v[108:109] op_sel:[1,1,0] op_sel_hi:[1,0,1] neg_lo:[0,1,0]
    ds_write_addtid_b32 v119 offset:30624
    v_cvt_pk_bf16_f32 v112, v30, v31
    v_pk_mul_f32 v[106:107], v[32:33], v[24:25] op_sel:[0,0] op_sel_hi:[0,1]
    v_cvt_pk_bf16_f32 v116, v40, v41
    v_pk_mul_f32 v[110:111], v[34:35], v[26:27] op_sel:[0,0] op_sel_hi:[0,1]
    ds_write_addtid_b32 v112 offset:8448
    v_pk_fma_f32 v[32:33], v[32:33], v[24:25], v[106:107] op_sel:[1,1,0] op_sel_hi:[1,0,1] neg_lo:[0,1,0]
    ds_write_addtid_b32 v116 offset:21120
    v_pk_fma_f32 v[34:35], v[34:35], v[26:27], v[110:111] op_sel:[1,1,0] op_sel_hi:[1,0,1] neg_lo:[0,1,0]
    v_pk_mul_f32 v[104:105], v[30:31], v[24:25] op_sel:[0,0] op_sel_hi:[0,1]
    v_cvt_pk_bf16_f32 v114, v32, v33
    v_pk_mul_f32 v[108:109], v[40:41], v[26:27] op_sel:[0,0] op_sel_hi:[0,1]
    v_cvt_pk_bf16_f32 v118, v34, v35
    v_pk_fma_f32 v[30:31], v[30:31], v[24:25], v[104:105] op_sel:[1,1,0] op_sel_hi:[1,0,1] neg_lo:[0,1,0]
    ds_write_addtid_b32 v114 offset:8976
    v_pk_fma_f32 v[40:41], v[40:41], v[26:27], v[108:109] op_sel:[1,1,0] op_sel_hi:[1,0,1] neg_lo:[0,1,0]
    ds_write_addtid_b32 v118 offset:22176
    s_waitcnt vmcnt(2)
    s_mov_b64 exec, 1
    buffer_store_dword v95, v76, s[32:35], s27 offen sc1
    s_mov_b64 exec, -1
    v_cvt_pk_bf16_f32 v113, v30, v31
    v_pk_mul_f32 v[106:107], v[32:33], v[24:25] op_sel:[0,0] op_sel_hi:[0,1]
    v_cvt_pk_bf16_f32 v117, v40, v41
    v_pk_mul_f32 v[110:111], v[38:39], v[26:27] op_sel:[0,0] op_sel_hi:[0,1]
    ds_write_addtid_b32 v113 offset:9504
    v_pk_fma_f32 v[32:33], v[32:33], v[24:25], v[106:107] op_sel:[1,1,0] op_sel_hi:[1,0,1] neg_lo:[0,1,0]
    ds_write_addtid_b32 v117 offset:23760
    v_pk_fma_f32 v[38:39], v[38:39], v[26:27], v[110:111] op_sel:[1,1,0] op_sel_hi:[1,0,1] neg_lo:[0,1,0]
    v_pk_mul_f32 v[104:105], v[30:31], v[24:25] op_sel:[0,0] op_sel_hi:[0,1]
    v_cvt_pk_bf16_f32 v115, v32, v33
    v_pk_mul_f32 v[108:109], v[40:41], v[26:27] op_sel:[0,0] op_sel_hi:[0,1]
    v_cvt_pk_bf16_f32 v119, v38, v39
    v_pk_fma_f32 v[30:31], v[30:31], v[24:25], v[104:105] op_sel:[1,1,0] op_sel_hi:[1,0,1] neg_lo:[0,1,0]
    ds_write_addtid_b32 v115 offset:10032
    v_pk_fma_f32 v[40:41], v[40:41], v[26:27], v[108:109] op_sel:[1,1,0] op_sel_hi:[1,0,1] neg_lo:[0,1,0]
    ds_write_addtid_b32 v119 offset:23232
    v_cvt_pk_bf16_f32 v112, v30, v31
    v_pk_mul_f32 v[106:107], v[32:33], v[24:25] op_sel:[0,0] op_sel_hi:[0,1]
    v_cvt_pk_bf16_f32 v116, v40, v41
    v_pk_mul_f32 v[110:111], v[36:37], v[26:27] op_sel:[0,0] op_sel_hi:[0,1]
    ds_write_addtid_b32 v112 offset:10560
    v_pk_fma_f32 v[32:33], v[32:33], v[24:25], v[106:107] op_sel:[1,1,0] op_sel_hi:[1,0,1] neg_lo:[0,1,0]
    ds_write_addtid_b32 v116 offset:25344
    v_pk_fma_f32 v[36:37], v[36:37], v[26:27], v[110:111] op_sel:[1,1,0] op_sel_hi:[1,0,1] neg_lo:[0,1,0]
    v_pk_mul_f32 v[104:105], v[30:31], v[24:25] op_sel:[0,0] op_sel_hi:[0,1]
    v_cvt_pk_bf16_f32 v114, v32, v33
    v_pk_mul_f32 v[108:109], v[40:41], v[26:27] op_sel:[0,0] op_sel_hi:[0,1]
    v_cvt_pk_bf16_f32 v118, v36, v37
    v_pk_fma_f32 v[30:31], v[30:31], v[24:25], v[104:105] op_sel:[1,1,0] op_sel_hi:[1,0,1] neg_lo:[0,1,0]
    ds_write_addtid_b32 v114 offset:11088
    v_pk_fma_f32 v[40:41], v[40:41], v[26:27], v[108:109] op_sel:[1,1,0] op_sel_hi:[1,0,1] neg_lo:[0,1,0]
    ds_write_addtid_b32 v118 offset:22704
    v_cvt_pk_bf16_f32 v113, v30, v31
    v_pk_mul_f32 v[106:107], v[32:33], v[24:25] op_sel:[0,0] op_sel_hi:[0,1]
    v_cvt_pk_bf16_f32 v117, v40, v41
    v_pk_mul_f32 v[110:111], v[36:37], v[26:27] op_sel:[0,0] op_sel_hi:[0,1]
    ds_write_addtid_b32 v113 offset:11616
    v_pk_fma_f32 v[32:33], v[32:33], v[24:25], v[106:107] op_sel:[1,1,0] op_sel_hi:[1,0,1] neg_lo:[0,1,0]
    ds_write_addtid_b32 v117 offset:26928
    v_pk_fma_f32 v[36:37], v[36:37], v[26:27], v[110:111] op_sel:[1,1,0] op_sel_hi:[1,0,1] neg_lo:[0,1,0]
    v_pk_mul_f32 v[104:105], v[30:31], v[24:25] op_sel:[0,0] op_sel_hi:[0,1]
    v_cvt_pk_bf16_f32 v115, v32, v33
    v_pk_mul_f32 v[108:109], v[40:41], v[26:27] op_sel:[0,0] op_sel_hi:[0,1]
    v_cvt_pk_bf16_f32 v119, v36, v37
    v_pk_fma_f32 v[30:31], v[30:31], v[24:25], v[104:105] op_sel:[1,1,0] op_sel_hi:[1,0,1] neg_lo:[0,1,0]
    ds_write_addtid_b32 v115 offset:12144
    v_pk_fma_f32 v[40:41], v[40:41], v[26:27], v[108:109] op_sel:[1,1,0] op_sel_hi:[1,0,1] neg_lo:[0,1,0]
    ds_write_addtid_b32 v119 offset:24816
    v_cvt_pk_bf16_f32 v112, v30, v31
    v_pk_mul_f32 v[106:107], v[32:33], v[24:25] op_sel:[0,0] op_sel_hi:[0,1]
    v_cvt_pk_bf16_f32 v116, v40, v41
    v_pk_mul_f32 v[110:111], v[36:37], v[26:27] op_sel:[0,0] op_sel_hi:[0,1]
    ds_write_addtid_b32 v112 offset:12672
    v_pk_fma_f32 v[32:33], v[32:33], v[24:25], v[106:107] op_sel:[1,1,0] op_sel_hi:[1,0,1] neg_lo:[0,1,0]
    ds_write_addtid_b32 v116 offset:27984
    v_pk_fma_f32 v[36:37], v[36:37], v[26:27], v[110:111] op_sel:[1,1,0] op_sel_hi:[1,0,1] neg_lo:[0,1,0]
    v_pk_mul_f32 v[104:105], v[30:31], v[24:25] op_sel:[0,0] op_sel_hi:[0,1]
    v_cvt_pk_bf16_f32 v114, v32, v33
    v_pk_mul_f32 v[108:109], v[40:41], v[26:27] op_sel:[0,0] op_sel_hi:[0,1]
    v_cvt_pk_bf16_f32 v118, v36, v37
    v_pk_fma_f32 v[30:31], v[30:31], v[24:25], v[104:105] op_sel:[1,1,0] op_sel_hi:[1,0,1] neg_lo:[0,1,0]
    ds_write_addtid_b32 v114 offset:13200
    v_pk_fma_f32 v[40:41], v[40:41], v[26:27], v[108:109] op_sel:[1,1,0] op_sel_hi:[1,0,1] neg_lo:[0,1,0]
    ds_write_addtid_b32 v118 offset:26400
    v_cvt_pk_bf16_f32 v113, v30, v31
    v_pk_mul_f32 v[106:107], v[32:33], v[24:25] op_sel:[0,0] op_sel_hi:[0,1]
    v_cvt_pk_bf16_f32 v117, v40, v41
    ds_write_addtid_b32 v113 offset:13728
    v_pk_fma_f32 v[32:33], v[32:33], v[24:25], v[106:107] op_sel:[1,1,0] op_sel_hi:[1,0,1] neg_lo:[0,1,0]
    ds_write_addtid_b32 v117 offset:29040
    v_pk_mul_f32 v[104:105], v[30:31], v[24:25] op_sel:[0,0] op_sel_hi:[0,1]
    v_cvt_pk_bf16_f32 v115, v32, v33
    v_pk_mul_f32 v[108:109], v[40:41], v[26:27] op_sel:[0,0] op_sel_hi:[0,1]
    v_pk_fma_f32 v[30:31], v[30:31], v[24:25], v[104:105] op_sel:[1,1,0] op_sel_hi:[1,0,1] neg_lo:[0,1,0]
    ds_write_addtid_b32 v115 offset:14256
    v_pk_fma_f32 v[40:41], v[40:41], v[26:27], v[108:109] op_sel:[1,1,0] op_sel_hi:[1,0,1] neg_lo:[0,1,0]
    v_cvt_pk_bf16_f32 v112, v30, v31
    v_pk_mul_f32 v[106:107], v[32:33], v[24:25] op_sel:[0,0] op_sel_hi:[0,1]
    v_cvt_pk_bf16_f32 v116, v40, v41
    ds_write_addtid_b32 v112 offset:14784
    s_waitcnt vmcnt(10)
    ds_read_b64_tr_b16 v[60:61], v46 offset:4096
    ds_read_b64_tr_b16 v[62:63], v46 offset:5120
    ds_read_b64_tr_b16 v[64:65], v46 offset:4104
    ds_read_b64_tr_b16 v[66:67], v46 offset:5128
    v_pk_fma_f32 v[32:33], v[32:33], v[24:25], v[106:107] op_sel:[1,1,0] op_sel_hi:[1,0,1] neg_lo:[0,1,0]
    ds_write_addtid_b32 v116 offset:30096
    v_pk_mul_f32 v[104:105], v[30:31], v[24:25] op_sel:[0,0] op_sel_hi:[0,1]
    v_cvt_pk_bf16_f32 v114, v32, v33
    v_pk_mul_f32 v[108:109], v[40:41], v[26:27] op_sel:[0,0] op_sel_hi:[0,1]
    v_pk_fma_f32 v[30:31], v[30:31], v[24:25], v[104:105] op_sel:[1,1,0] op_sel_hi:[1,0,1] neg_lo:[0,1,0]
    ds_write_addtid_b32 v114 offset:15312
    v_pk_fma_f32 v[40:41], v[40:41], v[26:27], v[108:109] op_sel:[1,1,0] op_sel_hi:[1,0,1] neg_lo:[0,1,0]
    v_cvt_pk_bf16_f32 v113, v30, v31
    v_pk_mul_f32 v[106:107], v[32:33], v[24:25] op_sel:[0,0] op_sel_hi:[0,1]
    s_waitcnt lgkmcnt(2)
    buffer_store_dwordx4 v[60:63], v3, s[32:35], s21 offen sc1
    s_add_u32 s21, s21, 1024
    buffer_store_dwordx4 v[64:67], v3, s[32:35], s21 offen sc1
    v_cvt_pk_bf16_f32 v117, v40, v41
    ds_write_addtid_b32 v113 offset:15840
    v_pk_fma_f32 v[32:33], v[32:33], v[24:25], v[106:107] op_sel:[1,1,0] op_sel_hi:[1,0,1] neg_lo:[0,1,0]
    ds_write_addtid_b32 v117 offset:31152
    v_cvt_pk_bf16_f32 v115, v32, v33
    ds_write_addtid_b32 v115 offset:16368
    v_and_b32 v21, 31, v1
    v_mul_u32_u24 v21, 528, v21
    v_lshrrev_b32 v22, 5, v1
    v_lshl_add_u32 v22, v22, 4, s44
    v_add_u32 v21, v21, v22
    v_add_u32 v20, v18, v22
    s_lshl_b32 s26, s40, 5
    s_add_u32 s26, s26, 24576
    s_cmp_eq_u32 s3, 3
    s_cselect_b32 s26, s26, 150994944
    s_waitcnt lgkmcnt(0)
    s_barrier
    ds_read_b128 v[128:131], v20 offset:0
    ds_read_b128 v[192:195], v21 offset:0
    ds_read_b128 v[132:135], v20 offset:32
    ds_read_b128 v[196:199], v21 offset:32
    ds_read_b128 v[136:139], v20 offset:64
    ds_read_b128 v[200:203], v21 offset:64
    ds_read_b128 v[140:143], v20 offset:96
    ds_read_b128 v[204:207], v21 offset:96
    ds_read_b128 v[144:147], v20 offset:128
    ds_read_b128 v[208:211], v21 offset:128
    ds_read_b128 v[148:151], v20 offset:160
    ds_read_b128 v[212:215], v21 offset:160
    v_and_b32 v22, 31, v1
    v_lshrrev_b32 v23, 5, v1
    v_lshl_add_u32 v22, v23, 6, v22
    v_lshlrev_b32 v22, 4, v22
    s_lshr_b32 s44, s3, 1
    s_mul_i32 s44, s44, 8320
    s_lshl_b32 s46, s45, 11
    s_sub_u32 s46, s44, s46
    s_add_u32 s46, s46, 69104
    v_sub_u32 v22, s46, v22
    s_cmp_eq_u32 s45, 0
    s_cselect_b32 s46, 0, 0xaaaaaaaa
    s_cselect_b32 s64, 1, 0
    s_mov_b32 s47, s46
    s_mov_b32 s65, 0
    v_mov_b32 v24, s43
    v_cndmask_b32 v23, 0, v24, s[64:65]
    s_add_u32 s66, s44, 73792
    v_mov_b32 v24, s66
    s_waitcnt lgkmcnt(10)
    v_mfma_f32_32x32x16_bf16 v[104:119], v[128:131], v[192:195], 0
    ds_read_b128 v[152:155], v20 offset:192
    ds_read_b128 v[216:219], v21 offset:192
    s_and_b32 s68, s40, 7
    s_mul_i32 s68, s68, 11
    s_min_u32 s68, s68, 76
    s_mul_i32 s69, s3, 3
    s_add_u32 s68, s68, s69
    s_lshr_b32 s69, s68, 1
    s_min_u32 s69, s69, 41
    s_lshl_b32 s69, s69, 9
    s_add_u32 s69, s69, 196608
    v_and_b32 v125, 31, v1
    v_lshlrev_b32 v124, 5, v125
    s_waitcnt lgkmcnt(10)
    v_mfma_f32_32x32x16_bf16 v[104:119], v[132:135], v[196:199], v[104:119]
    ds_read_b128 v[156:159], v20 offset:224
    ds_read_b128 v[220:223], v21 offset:224
    s_mul_i32 s66, s40, 12288
    s_add_u32 s66, s66, 14680064
    s_cmp_eq_u32 s63, 0
    s_cselect_b32 s66, s66, 4096
    v_lshlrev_b32 v25, 4, v0
    v_add_u32 v17, s66, v25
    v_lshlrev_b32 v26, 5, v0
    s_waitcnt lgkmcnt(10)
    v_mfma_f32_32x32x16_bf16 v[104:119], v[136:139], v[200:203], v[104:119]
    ds_read_b128 v[160:163], v20 offset:256
    ds_read_b128 v[224:227], v21 offset:256
    v_min_u32 v16, 23, v1
    v_lshlrev_b32 v16, 9, v16
    v_lshrrev_b32 v36, 2, v1
    v_cmp_eq_u32 vcc, 4, v36
    s_waitcnt lgkmcnt(10)
    v_mfma_f32_32x32x16_bf16 v[104:119], v[140:143], v[204:207], v[104:119]
    ds_read_b128 v[164:167], v20 offset:288
    ds_read_b128 v[228:231], v21 offset:288
    v_lshrrev_b32 v2, 3, v0
    v_lshlrev_b32 v2, 16, v2
    v_and_b32 v4, 0x70, v3
    s_lshl_b32 s66, s40, 7
    s_add_u32 s66, s66, 4194304
    v_add3_u32 v2, v2, v4, s66
    s_waitcnt lgkmcnt(10)
    v_mfma_f32_32x32x16_bf16 v[104:119], v[144:147], v[208:211], v[104:119]
    ds_read_b128 v[168:171], v20 offset:320
    ds_read_b128 v[232:235], v21 offset:320
    v_mov_b32 v120, -1
    v_mov_b32 v121, -1
    v_mov_b32 v122, -1
    v_mov_b32 v123, -1
    s_waitcnt lgkmcnt(10)
    v_mfma_f32_32x32x16_bf16 v[104:119], v[148:151], v[212:215], v[104:119]
    ds_read_b128 v[172:175], v20 offset:352
    ds_read_b128 v[236:239], v21 offset:352
    buffer_store_dwordx4 v[120:123], v2, s[32:35], 0 offen sc1
    buffer_store_dwordx4 v[120:123], v2, s[32:35], s56 offen sc1
    s_waitcnt lgkmcnt(10)
    v_mfma_f32_32x32x16_bf16 v[104:119], v[152:155], v[216:219], v[104:119]
    ds_read_b128 v[176:179], v20 offset:384
    ds_read_b128 v[240:243], v21 offset:384
    s_lshr_b32 s66, s40, 3
    s_lshl_b32 s66, s66, 12
    s_lshr_b32 s67, s3, 1
    s_lshl1_add_u32 s23, s40, s67
    s_lshl_b32 s23, s23, 8
    s_add_u32 s23, s23, s66
    s_lshl3_add_u32 s23, s45, s23
    s_add_u32 s23, s23, 262144
    v_and_b32 v4, 0xf0, v3
    v_and_b32 v5, 16, v1
    v_lshl_add_u32 v4, v5, 8, v4
    s_waitcnt lgkmcnt(10)
    v_mfma_f32_32x32x16_bf16 v[104:119], v[156:159], v[220:223], v[104:119]
    ds_read_b128 v[180:183], v20 offset:416
    ds_read_b128 v[244:247], v21 offset:416
    s_mov_b32 exec_hi, 0
    buffer_store_dwordx2 v[120:121], v4, s[32:35], s23 offen sc1
    s_mov_b32 exec_hi, -1
    s_waitcnt lgkmcnt(10)
    v_mfma_f32_32x32x16_bf16 v[104:119], v[160:163], v[224:227], v[104:119]
    ds_read_b128 v[184:187], v20 offset:448
    ds_read_b128 v[248:251], v21 offset:448
    v_mov_b32 v37, 0x2b800000
    v_cndmask_b32 v37, 0, v37, vcc
    v_cmp_eq_u32 s[66:67], 1, v36
    s_or_b64 vcc, vcc, s[66:67]
    buffer_load_dwordx4 v[88:91], v17, s[32:35], 0 offen sc1
    buffer_load_dwordx4 v[92:95], v17, s[32:35], s49 offen sc1
    s_waitcnt lgkmcnt(10)
    v_mfma_f32_32x32x16_bf16 v[104:119], v[164:167], v[228:231], v[104:119]
    ds_read_b128 v[188:191], v20 offset:480
    ds_read_b128 v[252:255], v21 offset:480
    v_cndmask_b32 v36, 0, 1.0, vcc
    buffer_load_dwordx4 v[96:99], v17, s[32:35], s50 offen sc1
    buffer_load_dwordx4 v[72:75], v25, s[32:35], s49 offen sc1
    s_waitcnt lgkmcnt(10)
    v_mfma_f32_32x32x16_bf16 v[104:119], v[168:171], v[232:235], v[104:119]
    v_lshrrev_b32 v28, 5, v1
    v_mul_u32_u24 v19, 2304, v28
    v_and_b32 v27, 15, v1
    v_lshl_add_u32 v19, v27, 4, v19
    buffer_load_dwordx4 v[76:79], v25, s[32:35], s50 offen sc1
    buffer_load_dwordx4 v[80:83], v25, s[32:35], s51 offen sc1
    s_waitcnt lgkmcnt(8)
    v_mfma_f32_32x32x16_bf16 v[104:119], v[172:175], v[236:239], v[104:119]
    v_bfe_u32 v29, v1, 4, 1
    v_lshl_add_u32 v19, v29, 3, v19
    s_lshl_b32 s66, s3, 8
    s_add_u32 s66, s66, 82416
    v_add_u32 v19, s66, v19
    buffer_load_dwordx4 v[84:87], v25, s[32:35], s52 offen sc1
    buffer_load_dwordx3 v[100:102], v16, s[32:35], s24 offen sc1
    s_waitcnt lgkmcnt(6)
    v_mfma_f32_32x32x16_bf16 v[104:119], v[176:179], v[240:243], v[104:119]
    v_add_u32 v27, v27, v28
    v_lshlrev_b32 v27, 4, v27
    v_mul_u32_u24 v29, 2304, v29
    buffer_load_dword v126, v124, s[32:35], s69 offen sc1
    s_waitcnt lgkmcnt(4)
    v_mfma_f32_32x32x16_bf16 v[104:119], v[180:183], v[244:247], v[104:119]
    s_lshr_b32 s66, s3, 1
    s_mul_i32 s66, s66, 4608
    s_lshl_b32 s67, s45, 7
    s_sub_u32 s66, s66, s67
    s_add_u32 s66, s66, 82304
    v_add3_u32 v27, v27, v29, s66
    s_waitcnt lgkmcnt(2)
    v_mfma_f32_32x32x16_bf16 v[104:119], v[184:187], v[248:251], v[104:119]
    s_waitcnt lgkmcnt(0)
    v_mfma_f32_32x32x16_bf16 v[104:119], v[188:191], v[252:255], v[104:119]
    v_and_b32 v20, 15, v1
    v_add_u32 v21, 1, v20
    v_lshrrev_b32 v21, 1, v21
    v_lshrrev_b32 v28, 4, v1
    v_lshlrev_b32 v28, 2, v28
    v_sub_u32 v21, v28, v21
    v_lshlrev_b32 v21, 2, v21
    v_and_b32 v20, 1, v20
    v_mul_u32_u24 v20, 4160, v20
    v_sub_u32 v21, v21, v20
    s_lshl_b32 s66, s45, 8
    s_sub_u32 s66, s44, s66
    s_add_u32 s66, s66, 73056
    v_add_u32 v20, s66, v21
    v_add_u32 v21, -1024, v20
    v_add_f32 v104, v104, v23
    v_cndmask_b32 v108, v108, v109, s[46:47]
    v_cndmask_b32 v116, v116, v117, s[46:47]
    v_cvt_pk_bf16_f32 v40, v111, v110
    v_cvt_pk_bf16_f32 v41, v109, v108
    v_cvt_pk_bf16_f32 v42, v107, v106
    v_cvt_pk_bf16_f32 v43, v105, v104
    ds_write_b128 v22, v[40:43] offset:512
    v_cvt_pk_bf16_f32 v44, v113, v111
    v_cvt_pk_bf16_f32 v45, v110, v109
    v_cvt_pk_bf16_f32 v46, v108, v107
    v_cvt_pk_bf16_f32 v47, v106, v105
    ds_write_b128 v22, v[44:47] offset:4672
    v_cvt_pk_bf16_f32 v48, v119, v118
    v_cvt_pk_bf16_f32 v49, v117, v116
    v_cvt_pk_bf16_f32 v50, v115, v114
    v_cvt_pk_bf16_f32 v51, v112, v112
    ds_write_b128 v22, v[48:51] offset:0
    v_cvt_pk_bf16_f32 v52, v119, v119
    v_cvt_pk_bf16_f32 v53, v118, v117
    v_cvt_pk_bf16_f32 v54, v116, v115
    v_cvt_pk_bf16_f32 v55, v114, v112
    ds_write_b128 v22, v[52:55] offset:4160
    v_cvt_pk_bf16_f32 v23, v104, 0
    s_mov_b64 exec, s[64:65]
    ds_write_b32 v24, v23
    s_mov_b64 exec, -1
    s_waitcnt lgkmcnt(0)
    v_add_u32 v22, -2048, v20
    v_add_u32 v23, -3072, v20
    s_barrier
    ds_read2_b32 a[0:1], v20 offset0:176 offset1:177
    ds_read2_b32 a[2:3], v20 offset0:178 offset1:179
    ds_read2_b32 a[4:5], v20 offset0:48 offset1:49
    ds_read2_b32 a[6:7], v20 offset0:50 offset1:51
    ds_read2_b32 a[8:9], v21 offset0:176 offset1:177
    ds_read2_b32 a[10:11], v21 offset0:178 offset1:179
    ds_read2_b32 a[12:13], v21 offset0:48 offset1:49
    ds_read2_b32 a[14:15], v21 offset0:50 offset1:51
    ds_read2_b32 a[16:17], v20 offset0:160 offset1:161
    ds_read2_b32 a[18:19], v20 offset0:162 offset1:163
    ds_read2_b32 a[20:21], v20 offset0:32 offset1:33
    ds_read2_b32 a[22:23], v20 offset0:34 offset1:35
    ds_read2_b32 a[24:25], v21 offset0:160 offset1:161
    ds_read2_b32 a[26:27], v21 offset0:162 offset1:163
    ds_read2_b32 a[28:29], v21 offset0:32 offset1:33
    ds_read2_b32 a[30:31], v21 offset0:34 offset1:35
    ds_read2_b32 a[32:33], v20 offset0:144 offset1:145
    ds_read2_b32 a[34:35], v20 offset0:146 offset1:147
    ds_read2_b32 a[36:37], v20 offset0:16 offset1:17
    ds_read2_b32 a[38:39], v20 offset0:18 offset1:19
    ds_read2_b32 a[40:41], v21 offset0:144 offset1:145
    ds_read2_b32 a[42:43], v21 offset0:146 offset1:147
    ds_read2_b32 a[44:45], v21 offset0:16 offset1:17
    ds_read2_b32 a[46:47], v21 offset0:18 offset1:19
    ds_read2_b32 a[48:49], v20 offset0:128 offset1:129
    ds_read2_b32 a[50:51], v20 offset0:130 offset1:131
    ds_read2_b32 a[52:53], v20 offset0:0 offset1:1
    ds_read2_b32 a[54:55], v20 offset0:2 offset1:3
    ds_read2_b32 a[56:57], v21 offset0:128 offset1:129
    ds_read2_b32 a[58:59], v21 offset0:130 offset1:131
    ds_read2_b32 a[60:61], v21 offset0:0 offset1:1
    ds_read2_b32 a[62:63], v21 offset0:2 offset1:3
    v_lshrrev_b32 v127, 5, v1
    v_add_u32 v127, s68, v127
    v_min_u32 v127, 85, v127
    v_lshlrev_b32 v125, 7, v125
    v_lshl_add_u32 v127, v127, 14, v125
    s_lshr_b32 s66, s31, 3
    s_lshl_b32 s66, s66, 12
    s_add_u32 s66, s66, 1048576
    s_add_u32 s67, s68, 2
    s_min_u32 s67, s67, 85
    s_lshl_b32 s67, s67, 14
    s_add_u32 s67, s67, s66
    s_waitcnt vmcnt(0)
    v_xor_b32 v29, s41, v91
    v_bitop3_b32 v29, v29, v95, s41 bitop3:0xf6
    v_bitop3_b32 v29, v29, v99, s41 bitop3:0xf6
    v_bitop3_b32 v29, v29, v75, s41 bitop3:0xf6
    v_bitop3_b32 v29, v29, v79, s41 bitop3:0xf6
    v_bitop3_b32 v29, v29, v83, s41 bitop3:0xf6
    v_bitop3_b32 v29, v29, v87, s41 bitop3:0xf6
    v_bitop3_b32 v29, v29, v102, s41 bitop3:0xf6
    v_bitop3_b32 v29, v29, v126, s41 bitop3:0xf6
    v_cmp_ne_u32 vcc, 0, v29
    s_cbranch_vccnz L_retry_3
L_back_4:
    buffer_load_dword v127, v127, s[32:35], s66 offen sc1
    buffer_load_dword v125, v125, s[32:35], s67 offen sc1
    s_cmp_lg_u32 s63, 0
    s_cbranch_scc1 L_gather
L_gathered:
    v_add_f32_dpp v100, v100, v100 quad_perm:[1,0,3,2] row_mask:0xf bank_mask:0xf
    v_lshlrev_b32 v56, 16, v88
    v_and_b32 v57, 0xffff0000, v88
    v_add_f32_dpp v101, v101, v101 quad_perm:[1,0,3,2] row_mask:0xf bank_mask:0xf
    v_lshlrev_b32 v58, 16, v89
    v_and_b32 v59, 0xffff0000, v89
    v_add_f32_dpp v100, v100, v100 quad_perm:[2,3,0,1] row_mask:0xf bank_mask:0xf
    v_lshlrev_b32 v60, 16, v90
    v_and_b32 v61, 0xffff0000, v90
    v_add_f32_dpp v101, v101, v101 quad_perm:[2,3,0,1] row_mask:0xf bank_mask:0xf
    v_lshlrev_b32 v62, 16, v92
    v_and_b32 v63, 0xffff0000, v92
    v_cvt_pk_bf16_f32 v101, v100, v101
    v_lshlrev_b32 v64, 16, v93
    v_and_b32 v65, 0xffff0000, v93
    v_lshlrev_b32 v100, 16, v101
    v_lshlrev_b32 v66, 16, v94
    v_and_b32 v67, 0xffff0000, v94
    v_and_b32 v101, 0xffff0000, v101
    v_lshlrev_b32 v68, 16, v96
    v_and_b32 v69, 0xffff0000, v96
    v_add_f32 v100, v100, v36
    v_lshlrev_b32 v70, 16, v97
    v_and_b32 v71, 0xffff0000, v97
    v_add_f32 v101, v101, v36
    v_lshlrev_b32 v40, 16, v74
    v_and_b32 v41, 0xffff0000, v74
    v_add_f32 v100, v100, v37
    v_lshlrev_b32 v42, 16, v78
    v_and_b32 v43, 0xffff0000, v78
    v_add_f32 v101, v101, v37
    v_lshlrev_b32 v44, 16, v82
    v_and_b32 v45, 0xffff0000, v82
    v_cvt_pk_bf16_f32 v100, v100, v101
    v_lshlrev_b32 v46, 16, v86
    v_and_b32 v47, 0xffff0000, v86
    v_readlane_b32 s12, v100, 0
    v_pk_add_f32 v[104:105], v[56:57], v[40:41] op_sel:[0,0] op_sel_hi:[1,0] neg_lo:[0,1] neg_hi:[0,1]
    v_readlane_b32 s13, v100, 4
    v_pk_add_f32 v[106:107], v[58:59], v[40:41] op_sel:[0,1] op_sel_hi:[1,1] neg_lo:[0,1] neg_hi:[0,1]
    v_readlane_b32 s14, v100, 8
    v_pk_add_f32 v[108:109], v[60:61], v[42:43] op_sel:[0,0] op_sel_hi:[1,0] neg_lo:[0,1] neg_hi:[0,1]
    v_readlane_b32 s16, v100, 16
    v_pk_add_f32 v[110:111], v[62:63], v[42:43] op_sel:[0,1] op_sel_hi:[1,1] neg_lo:[0,1] neg_hi:[0,1]
    v_readlane_b32 s15, v100, 12
    v_pk_add_f32 v[112:113], v[64:65], v[44:45] op_sel:[0,0] op_sel_hi:[1,0] neg_lo:[0,1] neg_hi:[0,1]
    v_readlane_b32 s17, v100, 20
    v_pk_add_f32 v[114:115], v[66:67], v[44:45] op_sel:[0,1] op_sel_hi:[1,1] neg_lo:[0,1] neg_hi:[0,1]
    v_pk_add_f32 v[116:117], v[68:69], v[46:47] op_sel:[0,0] op_sel_hi:[1,0] neg_lo:[0,1] neg_hi:[0,1]
    v_pk_add_f32 v[118:119], v[70:71], v[46:47] op_sel:[0,1] op_sel_hi:[1,1] neg_lo:[0,1] neg_hi:[0,1]
    s_lshl_b32 s4, s13, 16
    s_and_b32 s5, s13, 0xffff0000
    s_lshl_b32 s6, s16, 16
    s_and_b32 s7, s16, 0xffff0000
    s_lshl_b32 s8, s12, 16
    s_and_b32 s9, s12, 0xffff0000
    s_lshl_b32 s10, s14, 16
    s_and_b32 s11, s14, 0xffff0000
    v_mov_b32 v34, s8
    v_mov_b32 v35, s9
    v_pk_mul_f32 v[104:105], v[104:105], v[72:73] op_sel:[0,0] op_sel_hi:[1,0]
    v_pk_mul_f32 v[106:107], v[106:107], v[72:73] op_sel:[0,1] op_sel_hi:[1,1]
    v_pk_mul_f32 v[108:109], v[108:109], v[76:77] op_sel:[0,0] op_sel_hi:[1,0]
    v_pk_mul_f32 v[110:111], v[110:111], v[76:77] op_sel:[0,1] op_sel_hi:[1,1]
    v_pk_mul_f32 v[112:113], v[112:113], v[80:81] op_sel:[0,0] op_sel_hi:[1,0]
    v_pk_mul_f32 v[114:115], v[114:115], v[80:81] op_sel:[0,1] op_sel_hi:[1,1]
    v_pk_mul_f32 v[116:117], v[116:117], v[84:85] op_sel:[0,0] op_sel_hi:[1,0]
    v_pk_mul_f32 v[118:119], v[118:119], v[84:85] op_sel:[0,1] op_sel_hi:[1,1]
    v_pk_fma_f32 v[104:105], v[104:105], s[4:5], v[34:35]
    v_pk_fma_f32 v[106:107], v[106:107], s[4:5], v[34:35]
    v_pk_fma_f32 v[108:109], v[108:109], s[4:5], v[34:35]
    v_pk_fma_f32 v[110:111], v[110:111], s[4:5], v[34:35]
    v_cvt_pk_bf16_f32 v40, v104, v106
    v_cvt_pk_bf16_f32 v41, v108, v110
    ds_write_b64 v19, v[40:41] offset:0
    v_cvt_pk_bf16_f32 v42, v105, v107
    v_cvt_pk_bf16_f32 v43, v109, v111
    ds_write_b64 v19, v[42:43] offset:4608
    v_pk_fma_f32 v[112:113], v[112:113], s[4:5], v[34:35]
    v_pk_fma_f32 v[114:115], v[114:115], s[4:5], v[34:35]
    v_pk_fma_f32 v[116:117], v[116:117], s[4:5], v[34:35]
    v_pk_fma_f32 v[118:119], v[118:119], s[4:5], v[34:35]
    v_cvt_pk_bf16_f32 v44, v112, v114
    v_cvt_pk_bf16_f32 v45, v116, v118
    ds_write_b64 v19, v[44:45] offset:1024
    v_cvt_pk_bf16_f32 v46, v113, v115
    v_cvt_pk_bf16_f32 v47, v117, v119
    ds_write_b64 v19, v[46:47] offset:5632
    v_mov_b32 v28, s16
    v_mov_b32 v29, s15
    v_mov_b32 v30, s17
    s_xor_b32 s0, s63, s30
    s_xor_b32 s0, s0, s41
    v_mov_b32 v31, s0
    v_mov_b32 v15, s41
    v_mov_b32 v6, 0
    s_add_u32 s26, s26, 8192
    s_waitcnt lgkmcnt(0)
    s_barrier
    ds_read_b128 v[128:131], v27 offset:96
    ds_read_b128 v[132:135], v27 offset:352
    ds_read_b128 v[136:139], v27 offset:608
    ds_read_b128 v[140:143], v27 offset:864
    s_mov_b64 exec, 1
    buffer_store_dwordx4 v[28:31], v6, s[32:35], s26 offen sc1
    s_mov_b64 exec, -1
    ds_read_b128 v[144:147], v27 offset:64
    ds_read_b128 v[148:151], v27 offset:320
    ds_read_b128 v[152:155], v27 offset:576
    ds_read_b128 v[156:159], v27 offset:832
    s_lshr_b32 s44, s40, 3
    s_and_b32 s45, s40, 7
    s_mul_i32 s46, s45, 11
    s_cmp_eq_u32 s45, 7
    s_cselect_b32 s46, 76, s46
    s_cmp_lt_u32 s45, 6
    s_cselect_b32 s47, 11, 10
    s_add_u32 s47, s47, s46
    s_sub_u32 s64, s46, s47
    s_lshl_b32 s64, s64, 10
    s_add_u32 s64, s64, 12288
    s_bitcmp1_b32 s40, 0
    s_cselect_b32 s64, 0, s64
    s_mul_i32 s27, s40, 12288
    s_add_u32 s27, s27, s64
    s_mul_i32 s64, s3, 3
    s_add_u32 s46, s46, s64
    s_lshl_b32 s64, s64, 10
    s_add_u32 s27, s27, s64
    s_add_u32 s65, s46, 0
    s_lshl_b32 s66, s65, 14
    s_add_u32 s66, s66, 1048576
    s_cmp_lt_u32 s65, s47
    s_cselect_b32 s66, s66, 150994944
    v_add_u32 v8, s66, v3
    s_add_u32 s65, s46, 1
    s_lshl_b32 s66, s65, 14
    s_add_u32 s66, s66, 1048576
    s_cmp_lt_u32 s65, s47
    s_cselect_b32 s66, s66, 150994944
    v_add_u32 v9, s66, v3
    s_add_u32 s65, s46, 2
    s_lshl_b32 s66, s65, 14
    s_add_u32 s66, s66, 1048576
    s_cmp_lt_u32 s65, s47
    s_cselect_b32 s66, s66, 150994944
    v_add_u32 v10, s66, v3
    s_waitcnt lgkmcnt(7)
    v_mfma_f32_16x16x32_bf16 v[84:87], a[12:15], v[128:131], 0
    ds_read_b128 v[160:163], v27 offset:32
    s_add_u32 s65, s46, 0
    s_add_u32 s67, s27, 0
    s_cmp_lt_u32 s65, s47
    s_cselect_b32 s67, s67, 150994944
    v_add_u32 v12, s67, v3
    s_or_b32 s69, s40, s3
    s_cmp_eq_u32 s69, 0
    s_cselect_b32 s69, 0, 150994944
    buffer_store_dword v15, v6, s[32:35], s69 offen sc1
    v_mfma_f32_16x16x32_bf16 v[80:83], a[8:11], v[128:131], 0
    ds_read_b128 v[164:167], v27 offset:288
    s_add_u32 s65, s46, 1
    s_add_u32 s67, s27, 1024
    s_cmp_lt_u32 s65, s47
    s_cselect_b32 s67, s67, 150994944
    v_add_u32 v13, s67, v3
    s_waitcnt lgkmcnt(8)
    v_mfma_f32_16x16x32_bf16 v[84:87], a[8:11], v[132:135], v[84:87]
    ds_read_b128 v[168:171], v27 offset:544
    s_add_u32 s65, s46, 2
    s_add_u32 s67, s27, 2048
    s_cmp_lt_u32 s65, s47
    s_cselect_b32 s67, s67, 150994944
    v_add_u32 v14, s67, v3
    v_mfma_f32_16x16x32_bf16 v[76:79], a[4:7], v[128:131], 0
    ds_read_b128 v[172:175], v27 offset:800
    s_lshl_b32 s66, s3, 12
    s_add_u32 s66, s66, 91392
    v_add_u32 v24, s66, v3
    v_mfma_f32_16x16x32_bf16 v[80:83], a[4:7], v[132:135], v[80:83]
    ds_read_b128 v[176:179], v27 offset:0
    s_lshl_b32 s66, s3, 10
    s_add_u32 s66, s66, 91392
    v_add_u32 v25, s66, v3
    s_waitcnt lgkmcnt(10)
    v_mfma_f32_16x16x32_bf16 v[84:87], a[4:7], v[136:139], v[84:87]
    ds_read_b128 v[180:183], v27 offset:256
    v_mov_b32 v32, s10
    v_mfma_f32_16x16x32_bf16 v[72:75], a[0:3], v[128:131], 0
    ds_read_b128 v[184:187], v27 offset:512
    v_mov_b32 v33, s11
    v_mfma_f32_16x16x32_bf16 v[76:79], a[0:3], v[132:135], v[76:79]
    ds_read_b128 v[188:191], v27 offset:768
    v_mul_f32 v32, s6, v32
    v_mfma_f32_16x16x32_bf16 v[80:83], a[0:3], v[136:139], v[80:83]
    ds_read2_b32 v[192:193], v22 offset0:176 offset1:177
    v_mul_f32 v33, s7, v33
    s_waitcnt lgkmcnt(13)
    v_mfma_f32_16x16x32_bf16 v[84:87], a[0:3], v[140:143], v[84:87]
    ds_read2_b32 v[194:195], v22 offset0:178 offset1:179
    v_mul_f32 v56, s6, v56
    s_waitcnt lgkmcnt(13)
    v_mfma_f32_16x16x32_bf16 v[84:87], a[28:31], v[144:147], v[84:87]
    ds_read_b128 v[208:211], v27 offset:1120
    v_mul_f32 v57, s7, v57
    v_mfma_f32_16x16x32_bf16 v[80:83], a[24:27], v[144:147], v[80:83]
    ds_read2_b32 v[196:197], v22 offset0:48 offset1:49
    v_mul_f32 v58, s6, v58
    s_waitcnt lgkmcnt(14)
    v_mfma_f32_16x16x32_bf16 v[84:87], a[24:27], v[148:151], v[84:87]
    ds_read2_b32 v[198:199], v22 offset0:50 offset1:51
    v_mul_f32 v59, s7, v59
    v_mfma_f32_16x16x32_bf16 v[76:79], a[20:23], v[144:147], v[76:79]
    ds_read_b128 v[212:215], v27 offset:1376
    v_mul_f32 v60, s6, v60
    v_mfma_f32_16x16x32_bf16 v[80:83], a[20:23], v[148:151], v[80:83]
    ds_read2_b32 v[200:201], v23 offset0:176 offset1:177
    v_mul_f32 v61, s7, v61
    s_waitcnt lgkmcnt(15)
    v_mfma_f32_16x16x32_bf16 v[84:87], a[20:23], v[152:155], v[84:87]
    ds_read2_b32 v[202:203], v23 offset0:178 offset1:179
    v_mul_f32 v62, s6, v62
    v_mfma_f32_16x16x32_bf16 v[72:75], a[16:19], v[144:147], v[72:75]
    ds_read_b128 v[216:219], v27 offset:1632
    v_mul_f32 v63, s7, v63
    v_mfma_f32_16x16x32_bf16 v[76:79], a[16:19], v[148:151], v[76:79]
    ds_read2_b32 v[204:205], v23 offset0:48 offset1:49
    v_mul_f32 v64, s6, v64
    v_mfma_f32_16x16x32_bf16 v[80:83], a[16:19], v[152:155], v[80:83]
    ds_read2_b32 v[206:207], v23 offset0:50 offset1:51
    v_mul_f32 v65, s7, v65
    v_mfma_f32_16x16x32_bf16 v[84:87], a[16:19], v[156:159], v[84:87]
    ds_read_b128 v[220:223], v27 offset:1888
    v_mul_f32 v66, s6, v66
    s_waitcnt lgkmcnt(15)
    v_mfma_f32_16x16x32_bf16 v[84:87], a[44:47], v[160:163], v[84:87]
    ds_read2_b32 v[224:225], v22 offset0:160 offset1:161
    v_mul_f32 v67, s7, v67
    buffer_load_dwordx4 a[64:67], v8, s[32:35], 0 offen offset:0 sc1
    v_mfma_f32_16x16x32_bf16 v[80:83], a[40:43], v[160:163], v[80:83]
    ds_read2_b32 v[226:227], v22 offset0:162 offset1:163
    v_mul_f32 v68, s6, v68
    v_mfma_f32_16x16x32_bf16 v[84:87], a[40:43], v[164:167], v[84:87]
    ds_read_b128 v[240:243], v27 offset:1088
    v_mul_f32 v69, s7, v69
    buffer_load_dwordx4 a[68:71], v9, s[32:35], 0 offen offset:0 sc1
    v_mfma_f32_16x16x32_bf16 v[76:79], a[36:39], v[160:163], v[76:79]
    ds_read2_b32 v[228:229], v22 offset0:32 offset1:33
    v_mul_f32 v70, s6, v70
    v_mfma_f32_16x16x32_bf16 v[80:83], a[36:39], v[164:167], v[80:83]
    ds_read2_b32 v[230:231], v22 offset0:34 offset1:35
    v_mul_f32 v71, s7, v71
    v_mfma_f32_16x16x32_bf16 v[84:87], a[36:39], v[168:171], v[84:87]
    ds_read_b128 v[244:247], v27 offset:1344
    buffer_load_dwordx4 a[72:75], v10, s[32:35], 0 offen offset:0 sc1
    v_mfma_f32_16x16x32_bf16 v[72:75], a[32:35], v[160:163], v[72:75]
    ds_read2_b32 v[232:233], v23 offset0:160 offset1:161
    v_mfma_f32_16x16x32_bf16 v[76:79], a[32:35], v[164:167], v[76:79]
    ds_read2_b32 v[234:235], v23 offset0:162 offset1:163
    buffer_load_dwordx4 a[76:79], v8, s[32:35], 0 offen offset:1024 sc1
    v_mfma_f32_16x16x32_bf16 v[80:83], a[32:35], v[168:171], v[80:83]
    ds_read_b128 v[248:251], v27 offset:1600
    v_mfma_f32_16x16x32_bf16 v[84:87], a[32:35], v[172:175], v[84:87]
    ds_read2_b32 v[236:237], v23 offset0:32 offset1:33
    v_mfma_f32_16x16x32_bf16 v[84:87], a[60:63], v[176:179], v[84:87]
    ds_read2_b32 v[238:239], v23 offset0:34 offset1:35
    buffer_load_dwordx4 a[80:83], v9, s[32:35], 0 offen offset:1024 sc1
    v_mfma_f32_16x16x32_bf16 v[80:83], a[56:59], v[176:179], v[80:83]
    ds_read_b128 v[252:255], v27 offset:1856
    s_waitcnt lgkmcnt(15)
    v_mfma_f32_16x16x32_bf16 v[84:87], a[56:59], v[180:183], v[84:87]
    buffer_load_dwordx4 a[84:87], v10, s[32:35], 0 offen offset:1024 sc1
    v_mfma_f32_16x16x32_bf16 v[76:79], a[52:55], v[176:179], v[76:79]
    v_mfma_f32_16x16x32_bf16 v[80:83], a[52:55], v[180:183], v[80:83]
    v_mfma_f32_16x16x32_bf16 v[84:87], a[52:55], v[184:187], v[84:87]
    buffer_load_dwordx4 a[88:91], v8, s[32:35], 0 offen offset:2048 sc1
    v_mfma_f32_16x16x32_bf16 v[72:75], a[48:51], v[176:179], v[72:75]
    v_mfma_f32_16x16x32_bf16 v[76:79], a[48:51], v[180:183], v[76:79]
    buffer_load_dwordx4 a[92:95], v9, s[32:35], 0 offen offset:2048 sc1
    v_mfma_f32_16x16x32_bf16 v[80:83], a[48:51], v[184:187], v[80:83]
    v_mfma_f32_16x16x32_bf16 v[84:87], a[48:51], v[188:191], v[84:87]
    v_mfma_f32_16x16x32_bf16 v[88:91], a[4:7], v[140:143], 0
    buffer_load_dwordx4 a[96:99], v10, s[32:35], 0 offen offset:2048 sc1
    s_nop 1
    ds_write_b128 v24, v[72:75] offset:0
    v_mfma_f32_16x16x32_bf16 v[92:95], a[8:11], v[140:143], 0
    ds_write_b128 v24, v[76:79] offset:1024
    v_mfma_f32_16x16x32_bf16 v[88:91], a[8:11], v[136:139], v[88:91]
    ds_write_b128 v24, v[80:83] offset:2048
    v_mfma_f32_16x16x32_bf16 v[92:95], a[12:15], v[136:139], v[92:95]
    buffer_load_dwordx4 a[100:103], v8, s[32:35], 0 offen offset:3072 sc1
    ds_write_b128 v24, v[84:87] offset:3072
    v_mfma_f32_16x16x32_bf16 v[88:91], a[12:15], v[132:135], v[88:91]
    v_mfma_f32_16x16x32_bf16 v[96:99], a[12:15], v[140:143], 0
    buffer_load_dwordx4 a[104:107], v9, s[32:35], 0 offen offset:3072 sc1
    s_waitcnt lgkmcnt(15)
    v_mfma_f32_16x16x32_bf16 v[100:103], v[204:207], v[128:131], 0
    s_waitcnt lgkmcnt(0)
    s_barrier
    ds_read_b128 v[104:107], v25 offset:0
    ds_read_b128 v[108:111], v25 offset:4096
    ds_read_b128 v[112:115], v25 offset:8192
    ds_read_b128 v[116:119], v25 offset:12288
    v_mfma_f32_16x16x32_bf16 v[96:99], v[200:203], v[128:131], v[96:99]
    v_mfma_f32_16x16x32_bf16 v[100:103], v[200:203], v[132:135], v[100:103]
    buffer_load_dwordx4 a[108:111], v10, s[32:35], 0 offen offset:3072 sc1
    v_mfma_f32_16x16x32_bf16 v[96:99], v[196:199], v[132:135], v[96:99]
    v_mfma_f32_16x16x32_bf16 v[100:103], v[196:199], v[136:139], v[100:103]
    buffer_load_dwordx4 a[112:115], v8, s[32:35], s49 offen offset:0 sc1
    s_waitcnt lgkmcnt(3)
    v_fma_f32 v56, v104, v32, v56
    v_fma_f32 v58, v105, v32, v58
    v_mfma_f32_16x16x32_bf16 v[92:95], v[196:199], v[128:131], v[92:95]
    v_fma_f32 v60, v106, v32, v60
    v_fma_f32 v62, v107, v32, v62
    v_mfma_f32_16x16x32_bf16 v[100:103], v[192:195], v[140:143], v[100:103]
    s_waitcnt lgkmcnt(2)
    v_fma_f32 v56, v108, v32, v56
    v_fma_f32 v58, v109, v32, v58
    v_mfma_f32_16x16x32_bf16 v[96:99], v[192:195], v[136:139], v[96:99]
    buffer_load_dwordx4 a[116:119], v9, s[32:35], s49 offen offset:0 sc1
    v_fma_f32 v60, v110, v32, v60
    v_fma_f32 v62, v111, v32, v62
    v_mfma_f32_16x16x32_bf16 v[100:103], a[12:15], v[208:211], v[100:103]
    v_cvt_pk_bf16_f32 v40, v56, v58
    v_cvt_pk_bf16_f32 v41, v60, v62
    v_mfma_f32_16x16x32_bf16 v[92:95], v[192:195], v[132:135], v[92:95]
    buffer_load_dwordx4 a[120:123], v10, s[32:35], s49 offen offset:0 sc1
    s_waitcnt lgkmcnt(1)
    v_fma_f32 v57, v112, v33, v57
    v_fma_f32 v59, v113, v33, v59
    v_mfma_f32_16x16x32_bf16 v[96:99], a[8:11], v[208:211], v[96:99]
    v_fma_f32 v61, v114, v33, v61
    v_fma_f32 v63, v115, v33, v63
    v_mfma_f32_16x16x32_bf16 v[100:103], a[8:11], v[212:215], v[100:103]
    s_waitcnt lgkmcnt(0)
    v_fma_f32 v57, v116, v33, v57
    v_fma_f32 v59, v117, v33, v59
    v_mfma_f32_16x16x32_bf16 v[88:91], v[192:195], v[128:131], v[88:91]
    buffer_load_dwordx4 a[124:127], v8, s[32:35], s49 offen offset:1024 sc1
    v_fma_f32 v61, v118, v33, v61
    v_fma_f32 v63, v119, v33, v63
    v_mfma_f32_16x16x32_bf16 v[92:95], a[4:7], v[208:211], v[92:95]
    v_cvt_pk_bf16_f32 v42, v57, v59
    v_cvt_pk_bf16_f32 v43, v61, v63
    v_mfma_f32_16x16x32_bf16 v[96:99], a[4:7], v[212:215], v[96:99]
    buffer_store_dwordx4 v[40:43], v2, s[32:35], 0 offen sc1
    v_mfma_f32_16x16x32_bf16 v[100:103], a[4:7], v[216:219], v[100:103]
    buffer_load_dwordx4 a[128:131], v9, s[32:35], s49 offen offset:1024 sc1
    v_mfma_f32_16x16x32_bf16 v[88:91], a[0:3], v[208:211], v[88:91]
    v_mfma_f32_16x16x32_bf16 v[92:95], a[0:3], v[212:215], v[92:95]
    buffer_load_dwordx4 a[132:135], v10, s[32:35], s49 offen offset:1024 sc1
    v_mfma_f32_16x16x32_bf16 v[96:99], a[0:3], v[216:219], v[96:99]
    v_mfma_f32_16x16x32_bf16 v[100:103], a[0:3], v[220:223], v[100:103]
    v_mfma_f32_16x16x32_bf16 v[88:91], a[20:23], v[156:159], v[88:91]
    ds_read2_b32 v[192:193], v22 offset0:144 offset1:145
    buffer_load_dwordx4 a[136:139], v8, s[32:35], s49 offen offset:2048 sc1
    v_mfma_f32_16x16x32_bf16 v[92:95], a[24:27], v[156:159], v[92:95]
    ds_read2_b32 v[194:195], v22 offset0:146 offset1:147
    v_mfma_f32_16x16x32_bf16 v[88:91], a[24:27], v[152:155], v[88:91]
    ds_read_b128 v[208:211], v27 offset:1056
    buffer_load_dwordx4 a[140:143], v9, s[32:35], s49 offen offset:2048 sc1
    v_mfma_f32_16x16x32_bf16 v[92:95], a[28:31], v[152:155], v[92:95]
    ds_read2_b32 v[196:197], v22 offset0:16 offset1:17
    v_mfma_f32_16x16x32_bf16 v[88:91], a[28:31], v[148:151], v[88:91]
    ds_read2_b32 v[198:199], v22 offset0:18 offset1:19
    v_mfma_f32_16x16x32_bf16 v[96:99], a[28:31], v[156:159], v[96:99]
    ds_read_b128 v[212:215], v27 offset:1312
    buffer_load_dwordx4 a[144:147], v10, s[32:35], s49 offen offset:2048 sc1
    v_mfma_f32_16x16x32_bf16 v[100:103], v[236:239], v[144:147], v[100:103]
    ds_read2_b32 v[200:201], v23 offset0:144 offset1:145
    v_mfma_f32_16x16x32_bf16 v[96:99], v[232:235], v[144:147], v[96:99]
    ds_read2_b32 v[202:203], v23 offset0:146 offset1:147
    buffer_load_dwordx4 a[148:151], v8, s[32:35], s49 offen offset:3072 sc1
    v_mfma_f32_16x16x32_bf16 v[100:103], v[232:235], v[148:151], v[100:103]
    ds_read_b128 v[216:219], v27 offset:1568
    v_mfma_f32_16x16x32_bf16 v[96:99], v[228:231], v[148:151], v[96:99]
    ds_read2_b32 v[204:205], v23 offset0:16 offset1:17
    v_mfma_f32_16x16x32_bf16 v[100:103], v[228:231], v[152:155], v[100:103]
    ds_read2_b32 v[206:207], v23 offset0:18 offset1:19
    buffer_load_dwordx4 a[152:155], v9, s[32:35], s49 offen offset:3072 sc1
    v_mfma_f32_16x16x32_bf16 v[92:95], v[228:231], v[144:147], v[92:95]
    ds_read_b128 v[220:223], v27 offset:1824
    v_mfma_f32_16x16x32_bf16 v[100:103], v[224:227], v[156:159], v[100:103]
    buffer_load_dwordx4 a[156:159], v10, s[32:35], s49 offen offset:3072 sc1
    s_and_b32 s2, s44, 0
    s_lshl_b32 s2, s2, 1
    s_xor_b32 s2, s2, s3
    v_mfma_f32_16x16x32_bf16 v[96:99], v[224:227], v[152:155], v[96:99]
    s_cmp_eq_u32 s2, 3
    s_cselect_b32 s18, 150994944, s58
    s_cselect_b32 s19, 150994944, s53
    s_cselect_b32 s20, 10, 11
    v_mfma_f32_16x16x32_bf16 v[100:103], a[28:31], v[240:243], v[100:103]
    s_lshl2_add_u32 s21, s44, s2
    s_lshl1_add_u32 s21, s21, 1
    s_mul_i32 s21, s21, 12288
    s_lshl_b32 s20, s20, 10
    v_mfma_f32_16x16x32_bf16 v[92:95], v[224:227], v[148:151], v[92:95]
    buffer_load_dwordx4 a[160:163], v8, s[32:35], s50 offen offset:0 sc1
    s_sub_u32 s21, s21, s20
    s_and_b32 s20, s3, 1
    s_lshl_b32 s20, s20, 9
    s_add_u32 s22, s21, s20
    v_mfma_f32_16x16x32_bf16 v[96:99], a[24:27], v[240:243], v[96:99]
    s_lshl_b32 s36, s44, 8
    s_add_u32 s36, s36, 40960
    s_lshl2_add_u32 s1, s45, s3
    s_lshl2_add_u32 s1, s1, s36
    v_mfma_f32_16x16x32_bf16 v[100:103], a[24:27], v[244:247], v[100:103]
    s_lshl_b32 s26, s2, 5
    s_add_u32 s26, s26, s36
    s_lshl_b32 s24, s44, 13
    s_add_u32 s24, s24, 262144
    v_mfma_f32_16x16x32_bf16 v[88:91], v[224:227], v[144:147], v[88:91]
    buffer_load_dwordx4 a[164:167], v9, s[32:35], s50 offen offset:0 sc1
    s_add_u32 s25, s24, 4096
    s_xor_b32 s0, s41, s30
    v_mfma_f32_16x16x32_bf16 v[92:95], a[20:23], v[240:243], v[92:95]
    s_mul_i32 s37, s45, 43
    s_mul_i32 s38, s2, 11
    s_add_u32 s37, s37, s38
    s_lshl_b32 s37, s37, 12
    v_mfma_f32_16x16x32_bf16 v[96:99], a[20:23], v[244:247], v[96:99]
    buffer_load_dwordx4 a[168:171], v10, s[32:35], s50 offen offset:0 sc1
    s_add_u32 s37, s37, 2621440
    s_lshr_b32 s38, s3, 1
    s_lshl_b32 s38, s38, 11
    s_or_b32 s37, s37, s38
    v_mfma_f32_16x16x32_bf16 v[100:103], a[20:23], v[248:251], v[100:103]
    s_lshl_b32 s12, s44, 16
    s_add_u32 s12, s12, 4194304
    s_mul_i32 s13, s44, 22528
    s_add_u32 s13, s13, 11534336
    v_mfma_f32_16x16x32_bf16 v[88:91], a[16:19], v[240:243], v[88:91]
    s_min_u32 s39, s2, 2
    s_mul_i32 s39, s39, 22528
    s_add_u32 s39, s39, s12
    s_mov_b32 s14, 8388608
    v_mfma_f32_16x16x32_bf16 v[92:95], a[16:19], v[244:247], v[92:95]
    buffer_load_dwordx4 a[172:175], v8, s[32:35], s50 offen offset:1024 sc1
    s_cmp_eq_u32 s2, 2
    s_cselect_b32 s39, s13, s39
    s_cselect_b32 s15, 4289724416, s14
    s_sub_u32 s39, s39, s21
    v_mfma_f32_16x16x32_bf16 v[96:99], a[16:19], v[248:251], v[96:99]
    s_lshr_b32 s16, s45, 1
    s_min_u32 s38, s16, 2
    s_mul_i32 s38, s38, 22528
    s_add_u32 s38, s38, s12
    v_mfma_f32_16x16x32_bf16 v[100:103], a[16:19], v[252:255], v[100:103]
    buffer_load_dwordx4 a[176:179], v9, s[32:35], s50 offen offset:1024 sc1
    s_cmp_eq_u32 s16, 2
    s_cselect_b32 s38, s13, s38
    s_cselect_b32 s14, 4289724416, s14
    s_or_b32 s17, s40, 1
    v_mfma_f32_16x16x32_bf16 v[88:91], a[36:39], v[172:175], v[88:91]
    ds_read2_b32 v[224:225], v22 offset0:128 offset1:129
    s_cmp_eq_u32 s16, 3
    s_cselect_b32 s16, 10, 11
    s_mul_i32 s17, s17, 12288
    s_lshl_b32 s16, s16, 10
    v_mfma_f32_16x16x32_bf16 v[92:95], a[40:43], v[172:175], v[92:95]
    ds_read2_b32 v[226:227], v22 offset0:130 offset1:131
    s_sub_u32 s17, s17, s16
    s_sub_u32 s38, s38, s17
    v_mfma_f32_16x16x32_bf16 v[88:91], a[40:43], v[168:171], v[88:91]
    ds_read_b128 v[240:243], v27 offset:1024
    buffer_load_dwordx4 a[180:183], v10, s[32:35], s50 offen offset:1024 sc1
    v_mfma_f32_16x16x32_bf16 v[92:95], a[44:47], v[168:171], v[92:95]
    ds_read2_b32 v[228:229], v22 offset0:0 offset1:1
    v_mfma_f32_16x16x32_bf16 v[88:91], a[44:47], v[164:167], v[88:91]
    ds_read2_b32 v[230:231], v22 offset0:2 offset1:3
    buffer_load_dwordx4 a[184:187], v8, s[32:35], s50 offen offset:2048 sc1
    v_mfma_f32_16x16x32_bf16 v[96:99], a[44:47], v[172:175], v[96:99]
    ds_read_b128 v[244:247], v27 offset:1280
    s_waitcnt lgkmcnt(7)
    v_mfma_f32_16x16x32_bf16 v[100:103], v[204:207], v[160:163], v[100:103]
    ds_read2_b32 v[232:233], v23 offset0:128 offset1:129
    v_mfma_f32_16x16x32_bf16 v[96:99], v[200:203], v[160:163], v[96:99]
    ds_read2_b32 v[234:235], v23 offset0:130 offset1:131
    buffer_load_dwordx4 a[188:191], v9, s[32:35], s50 offen offset:2048 sc1
    v_mfma_f32_16x16x32_bf16 v[100:103], v[200:203], v[164:167], v[100:103]
    ds_read_b128 v[248:251], v27 offset:1536
    buffer_load_dwordx4 v[52:55], v26, s[32:35], s56 offen sc1
    v_mfma_f32_16x16x32_bf16 v[96:99], v[196:199], v[164:167], v[96:99]
    ds_read2_b32 v[236:237], v23 offset0:0 offset1:1
    v_mfma_f32_16x16x32_bf16 v[100:103], v[196:199], v[168:171], v[100:103]
    ds_read2_b32 v[238:239], v23 offset0:2 offset1:3
    buffer_load_dwordx4 a[192:195], v10, s[32:35], s50 offen offset:2048 sc1
    v_mfma_f32_16x16x32_bf16 v[92:95], v[196:199], v[160:163], v[92:95]
    ds_read_b128 v[252:255], v27 offset:1792
    v_mfma_f32_16x16x32_bf16 v[100:103], v[192:195], v[172:175], v[100:103]
    buffer_load_dwordx4 a[196:199], v8, s[32:35], s50 offen offset:3072 sc1
    v_lshlrev_b32 v19, 2, v0
    v_add_u32 v19, 132352, v19
    s_mov_b32 s69, 1048576
    v_mfma_f32_16x16x32_bf16 v[96:99], v[192:195], v[168:171], v[96:99]
    v_mfma_f32_16x16x32_bf16 v[100:103], a[44:47], v[208:211], v[100:103]
    s_lshl_b32 s66, s44, 16
    s_add_u32 s66, s66, 4194304
    v_lshl_add_u32 v16, v0, 4, s66
    v_mfma_f32_16x16x32_bf16 v[92:95], v[192:195], v[164:167], v[92:95]
    buffer_load_dwordx4 a[200:203], v9, s[32:35], s50 offen offset:3072 sc1
    v_and_b32 v4, 32, v1
    v_mfma_f32_16x16x32_bf16 v[96:99], a[40:43], v[208:211], v[96:99]
    v_lshlrev_b32 v18, 4, v0
    v_mfma_f32_16x16x32_bf16 v[100:103], a[40:43], v[212:215], v[100:103]
    buffer_load_dwordx4 a[204:207], v10, s[32:35], s50 offen offset:3072 sc1
    v_lshlrev_b32 v5, 1, v4
    v_mfma_f32_16x16x32_bf16 v[88:91], v[192:195], v[160:163], v[88:91]
    v_xor_b32 v18, v18, v5
    v_mfma_f32_16x16x32_bf16 v[92:95], a[36:39], v[208:211], v[92:95]
    v_and_b32 v5, 16, v1
    v_mfma_f32_16x16x32_bf16 v[96:99], a[36:39], v[212:215], v[96:99]
    buffer_load_dwordx4 a[208:211], v8, s[32:35], s51 offen offset:0 sc1
    v_mul_u32_u24 v28, 36, v5
    v_mfma_f32_16x16x32_bf16 v[100:103], a[36:39], v[216:219], v[100:103]
    v_and_b32 v7, 8, v1
    v_mfma_f32_16x16x32_bf16 v[88:91], a[32:35], v[208:211], v[88:91]
    buffer_load_dwordx4 a[212:215], v9, s[32:35], s51 offen offset:0 sc1
    v_lshl_add_u32 v28, v7, 4, v28
    v_mfma_f32_16x16x32_bf16 v[92:95], a[32:35], v[212:215], v[92:95]
    v_and_b32 v7, 48, v3
    v_mfma_f32_16x16x32_bf16 v[96:99], a[32:35], v[216:219], v[96:99]
    v_add_u32 v28, v28, v7
    s_waitcnt lgkmcnt(12)
    v_mfma_f32_16x16x32_bf16 v[100:103], a[32:35], v[220:223], v[100:103]
    buffer_load_dwordx4 a[216:219], v10, s[32:35], s51 offen offset:0 sc1
    v_and_b32 v7, 4, v1
    v_mfma_f32_16x16x32_bf16 v[92:95], a[56:59], v[188:191], v[92:95]
    v_lshl_add_u32 v28, v7, 1, v28
    v_mfma_f32_16x16x32_bf16 v[88:91], a[52:55], v[188:191], v[88:91]
    buffer_load_dwordx4 a[220:223], v8, s[32:35], s51 offen offset:1024 sc1
    s_lshr_b32 s66, s3, 1
    s_lshl1_add_u32 s66, s45, s66
    s_lshl_b32 s67, s66, 11
    v_lshl_add_u32 v30, v4, 5, v28
    v_mfma_f32_16x16x32_bf16 v[92:95], a[60:63], v[184:187], v[92:95]
    s_and_b32 s68, s3, 1
    s_lshl_b32 s68, s68, 6
    s_or_b32 s67, s67, s68
    v_xor_b32 v30, s67, v30
    v_mfma_f32_16x16x32_bf16 v[88:91], a[56:59], v[184:187], v[88:91]
    v_lshl_add_u32 v28, v4, 3, v28
    s_waitcnt lgkmcnt(7)
    v_mfma_f32_16x16x32_bf16 v[92:95], v[228:231], v[176:179], v[92:95]
    buffer_load_dwordx4 a[224:227], v9, s[32:35], s51 offen offset:1024 sc1
    v_xor_b32 v29, 64, v28
    v_mfma_f32_16x16x32_bf16 v[88:91], a[60:63], v[180:183], v[88:91]
    v_lshrrev_b32 v4, 2, v4
    v_mfma_f32_16x16x32_bf16 v[92:95], v[224:227], v[180:183], v[92:95]
    v_and_b32 v7, 1, v1
    v_mfma_f32_16x16x32_bf16 v[88:91], v[224:227], v[176:179], v[88:91]
    buffer_load_dwordx4 a[228:231], v10, s[32:35], s51 offen offset:1024 sc1
    v_lshl_add_u32 v34, v7, 10, v4
    v_mfma_f32_16x16x32_bf16 v[92:95], a[52:55], v[240:243], v[92:95]
    v_add_u32 v5, 132352, v5
    v_mfma_f32_16x16x32_bf16 v[88:91], a[48:51], v[240:243], v[88:91]
    buffer_load_dwordx4 a[232:235], v8, s[32:35], s51 offen offset:2048 sc1
    v_add_u32 v34, v34, v5
    s_waitcnt lgkmcnt(1)
    v_mfma_f32_16x16x32_bf16 v[100:103], v[236:239], v[176:179], v[100:103]
    s_lshl_b32 s66, s66, 6
    s_add_u32 s66, s66, 132352
    v_and_b32 v35, 48, v1
    v_mfma_f32_16x16x32_bf16 v[92:95], a[48:51], v[244:247], v[92:95]
    v_add_u32 v35, s66, v35
    v_mfma_f32_16x16x32_bf16 v[96:99], a[60:63], v[188:191], v[96:99]
    buffer_load_dwordx4 a[236:239], v9, s[32:35], s51 offen offset:2048 sc1
    s_lshl_b32 s66, s44, 5
    s_add_u32 s66, s66, 135424
    v_and_b32 v31, 7, v1
    v_mfma_f32_16x16x32_bf16 v[100:103], v[232:235], v[180:183], v[100:103]
    ds_write_b128 v24, v[88:91] offset:16384
    v_lshlrev_b32 v31, 2, v31
    v_mfma_f32_16x16x32_bf16 v[96:99], v[232:235], v[176:179], v[96:99]
    buffer_load_dwordx4 a[240:243], v10, s[32:35], s51 offen offset:2048 sc1
    v_add_u32 v11, s66, v31
    v_mfma_f32_16x16x32_bf16 v[100:103], v[228:231], v[184:187], v[100:103]
    ds_write_b128 v24, v[92:95] offset:17408
    v_mfma_f32_16x16x32_bf16 v[96:99], v[228:231], v[180:183], v[96:99]
    v_mfma_f32_16x16x32_bf16 v[100:103], v[224:227], v[188:191], v[100:103]
    buffer_load_dwordx4 a[244:247], v8, s[32:35], s51 offen offset:3072 sc1
    v_mfma_f32_16x16x32_bf16 v[96:99], v[224:227], v[184:187], v[96:99]
    v_mfma_f32_16x16x32_bf16 v[100:103], a[60:63], v[240:243], v[100:103]
    buffer_load_dwordx4 a[248:251], v9, s[32:35], s51 offen offset:3072 sc1
    v_mfma_f32_16x16x32_bf16 v[96:99], a[56:59], v[240:243], v[96:99]
    v_mfma_f32_16x16x32_bf16 v[100:103], a[56:59], v[244:247], v[100:103]
    v_mfma_f32_16x16x32_bf16 v[96:99], a[52:55], v[244:247], v[96:99]
    buffer_load_dwordx4 a[252:255], v10, s[32:35], s51 offen offset:3072 sc1
    v_mfma_f32_16x16x32_bf16 v[100:103], a[52:55], v[248:251], v[100:103]
    s_waitcnt vmcnt(16)
    v_xor_b32 v7, s41, v55
    v_cmp_lt_u32 vcc, 15, v7
    s_cbranch_vccnz L_retry_5
L_back_6:
    ds_write2st64_b32 v19, v52, v53 offset0:0 offset1:4
    ds_write2st64_b32 v19, v54, v55 offset0:8 offset1:12
    v_mfma_f32_16x16x32_bf16 v[96:99], a[48:51], v[248:251], v[96:99]
    s_waitcnt lgkmcnt(4)
    v_mfma_f32_16x16x32_bf16 v[100:103], a[48:51], v[252:255], v[100:103]
    s_nop 5
    ds_write_b128 v24, v[96:99] offset:18432
    s_nop 0
    ds_write_b128 v24, v[100:103] offset:19456
    s_waitcnt lgkmcnt(0)
    s_barrier
    ds_read_b128 v[104:107], v25 offset:16384
    ds_read_b128 v[108:111], v25 offset:20480
    ds_read_b128 v[112:115], v25 offset:24576
    ds_read_b128 v[116:119], v25 offset:28672
    ds_read_b128 v[140:143], v35
    ds_read_b32 v11, v11
    buffer_load_dwordx4 v[216:219], v16, s[32:35], 0 offen sc1
    buffer_load_dwordx4 v[220:223], v16, s[32:35], s49 offen sc1
    buffer_load_dwordx4 v[224:227], v16, s[32:35], s50 offen sc1
    buffer_load_dwordx4 v[228:231], v16, s[32:35], s51 offen sc1
    buffer_load_dwordx4 v[232:235], v16, s[32:35], s52 offen sc1
    buffer_load_dwordx4 v[236:239], v16, s[32:35], s53 offen sc1
    buffer_load_dwordx4 v[240:243], v16, s[32:35], s54 offen sc1
    buffer_load_dwordx4 v[244:247], v16, s[32:35], s55 offen sc1
    v_add_u32 v5, s37, v3
    v_xor_b32 v4, 0x800, v5
    s_waitcnt lgkmcnt(5)
    v_fma_f32 v64, v104, v32, v64
    v_fma_f32 v66, v105, v32, v66
    v_fma_f32 v68, v106, v32, v68
    v_fma_f32 v70, v107, v32, v70
    s_waitcnt lgkmcnt(4)
    v_fma_f32 v64, v108, v32, v64
    v_fma_f32 v66, v109, v32, v66
    v_fma_f32 v68, v110, v32, v68
    v_fma_f32 v70, v111, v32, v70
    v_cvt_pk_bf16_f32 v40, v64, v66
    v_cvt_pk_bf16_f32 v41, v68, v70
    s_waitcnt lgkmcnt(3)
    v_fma_f32 v65, v112, v33, v65
    v_fma_f32 v67, v113, v33, v67
    v_fma_f32 v69, v114, v33, v69
    v_fma_f32 v71, v115, v33, v71
    s_waitcnt lgkmcnt(2)
    v_fma_f32 v65, v116, v33, v65
    v_fma_f32 v67, v117, v33, v67
    v_fma_f32 v69, v118, v33, v69
    v_fma_f32 v71, v119, v33, v71
    v_cvt_pk_bf16_f32 v42, v65, v67
    v_cvt_pk_bf16_f32 v43, v69, v71
    buffer_store_dwordx4 v[40:43], v2, s[32:35], s56 offen sc1
    ds_read2_b64 v[116:119], v34 offset0:0 offset1:4
    v_and_b32 v32, 1, v1
    v_lshlrev_b32 v32, 7, v32
    v_and_b32 v33, 2, v1
    v_lshl_add_u32 v33, v33, 11, v32
    s_mov_b64 exec, 15
    buffer_load_dword v33, v33, s[32:35], s23 offen sc1
    buffer_load_dword v32, v32, s[32:35], s36 offen sc1
    s_mov_b64 exec, -1
    s_waitcnt lgkmcnt(0)
    v_mfma_f32_16x16x32_bf16 v[48:51], a[64:67], v[116:119], 0
    ds_read2_b64 v[120:123], v34 offset0:8 offset1:12
    buffer_load_dwordx4 a[0:3], v4, s[32:35], 0 offen offset:0 sc1
    v_mfma_f32_16x16x32_bf16 v[52:55], a[68:71], v[116:119], 0
    buffer_load_dwordx4 a[4:7], v4, s[32:35], 0 offen offset:1024 sc1
    v_cmp_ne_u32 vcc, s0, v11
    s_mov_b32 s63, vcc_lo
    s_cmp_eq_u32 s63, 0
    s_cselect_b32 s20, 14680064, 0
    s_cselect_b32 s14, 0, s14
    s_cselect_b32 s15, 0, s15
    s_max_u32 s20, s20, 8388608
    v_mfma_f32_16x16x32_bf16 v[56:59], a[72:75], v[116:119], 0
    s_add_u32 s21, s38, s14
    s_add_u32 s39, s39, s15
    s_waitcnt lgkmcnt(0)
    v_mfma_f32_16x16x32_bf16 v[48:51], a[76:79], v[120:123], v[48:51]
    ds_read2_b64 v[116:119], v34 offset0:16 offset1:20
    buffer_load_dwordx4 a[8:11], v4, s[32:35], s49 offen offset:0 sc1
    v_mfma_f32_16x16x32_bf16 v[52:55], a[80:83], v[120:123], v[52:55]
    v_lshlrev_b32 v20, 16, v140
    v_and_b32 v21, 0xffff0000, v140
    v_rcp_f32 v20, v20
    v_rcp_f32 v21, v21
    v_mfma_f32_16x16x32_bf16 v[56:59], a[84:87], v[120:123], v[56:59]
    buffer_load_dwordx4 a[12:15], v4, s[32:35], s49 offen offset:1024 sc1
    s_waitcnt lgkmcnt(0)
    v_mfma_f32_16x16x32_bf16 v[48:51], a[88:91], v[116:119], v[48:51]
    ds_read2_b64 v[120:123], v34 offset0:24 offset1:28
    v_lshlrev_b32 v22, 16, v141
    v_and_b32 v23, 0xffff0000, v141
    v_rcp_f32 v22, v22
    v_rcp_f32 v23, v23
    v_mfma_f32_16x16x32_bf16 v[52:55], a[92:95], v[116:119], v[52:55]
    buffer_load_dwordx4 a[16:19], v4, s[32:35], s50 offen offset:0 sc1
    v_lshlrev_b32 v24, 16, v142
    v_and_b32 v25, 0xffff0000, v142
    v_rcp_f32 v24, v24
    v_rcp_f32 v25, v25
    v_mfma_f32_16x16x32_bf16 v[56:59], a[96:99], v[116:119], v[56:59]
    v_lshlrev_b32 v26, 16, v143
    v_and_b32 v27, 0xffff0000, v143
    v_rcp_f32 v26, v26
    v_rcp_f32 v27, v27
    s_waitcnt lgkmcnt(0)
    v_mfma_f32_16x16x32_bf16 v[48:51], a[100:103], v[120:123], v[48:51]
    ds_read2_b64 v[116:119], v34 offset0:32 offset1:36
    buffer_load_dwordx4 a[20:23], v4, s[32:35], s50 offen offset:1024 sc1
    v_mfma_f32_16x16x32_bf16 v[52:55], a[104:107], v[120:123], v[52:55]
    v_add_u32 v17, s56, v16
    v_and_b32 v19, 0xf0, v3
    v_mfma_f32_16x16x32_bf16 v[56:59], a[108:111], v[120:123], v[56:59]
    buffer_load_dwordx4 a[24:27], v4, s[32:35], s51 offen offset:0 sc1
    s_waitcnt lgkmcnt(0)
    v_mfma_f32_16x16x32_bf16 v[48:51], a[112:115], v[116:119], v[48:51]
    ds_read2_b64 v[120:123], v34 offset0:40 offset1:44
    s_add_u32 s22, s22, s20
    v_and_b32 v7, 32, v1
    v_lshl_add_u32 v7, v7, 4, v3
    v_add_u32 v7, s22, v7
    v_xor_b32 v6, 0x200, v7
    s_sub_u32 s22, s39, s20
    v_mfma_f32_16x16x32_bf16 v[52:55], a[116:119], v[116:119], v[52:55]
    buffer_load_dwordx4 a[28:31], v4, s[32:35], s51 offen offset:1024 sc1
    v_mfma_f32_16x16x32_bf16 v[56:59], a[120:123], v[116:119], v[56:59]
    s_waitcnt lgkmcnt(0)
    v_mfma_f32_16x16x32_bf16 v[48:51], a[124:127], v[120:123], v[48:51]
    ds_read2_b64 v[116:119], v34 offset0:48 offset1:52
    buffer_load_dwordx4 a[32:35], v4, s[32:35], s52 offen offset:0 sc1
    v_mfma_f32_16x16x32_bf16 v[52:55], a[128:131], v[120:123], v[52:55]
    v_mfma_f32_16x16x32_bf16 v[56:59], a[132:135], v[120:123], v[56:59]
    buffer_load_dwordx4 a[36:39], v4, s[32:35], s52 offen offset:1024 sc1
    s_waitcnt lgkmcnt(0)
    v_mfma_f32_16x16x32_bf16 v[48:51], a[136:139], v[116:119], v[48:51]
    ds_read2_b64 v[120:123], v34 offset0:56 offset1:60
    v_mfma_f32_16x16x32_bf16 v[52:55], a[140:143], v[116:119], v[52:55]
    v_mfma_f32_16x16x32_bf16 v[56:59], a[144:147], v[116:119], v[56:59]
    s_waitcnt lgkmcnt(0)
    v_mfma_f32_16x16x32_bf16 v[48:51], a[148:151], v[120:123], v[48:51]
    ds_read2_b64 v[116:119], v34 offset0:64 offset1:68
    v_mfma_f32_16x16x32_bf16 v[52:55], a[152:155], v[120:123], v[52:55]
    v_mfma_f32_16x16x32_bf16 v[56:59], a[156:159], v[120:123], v[56:59]
    s_waitcnt lgkmcnt(0)
    v_mfma_f32_16x16x32_bf16 v[48:51], a[160:163], v[116:119], v[48:51]
    ds_read2_b64 v[120:123], v34 offset0:72 offset1:76
    v_mfma_f32_16x16x32_bf16 v[52:55], a[164:167], v[116:119], v[52:55]
    v_mfma_f32_16x16x32_bf16 v[56:59], a[168:171], v[116:119], v[56:59]
    s_waitcnt lgkmcnt(0)
    v_mfma_f32_16x16x32_bf16 v[48:51], a[172:175], v[120:123], v[48:51]
    ds_read2_b64 v[116:119], v34 offset0:80 offset1:84
    v_mfma_f32_16x16x32_bf16 v[52:55], a[176:179], v[120:123], v[52:55]
    v_mfma_f32_16x16x32_bf16 v[56:59], a[180:183], v[120:123], v[56:59]
    s_waitcnt vmcnt(36)
    s_waitcnt lgkmcnt(0)
    v_mfma_f32_16x16x32_bf16 v[48:51], a[184:187], v[116:119], v[48:51]
    ds_read2_b64 v[120:123], v34 offset0:88 offset1:92
    v_mfma_f32_16x16x32_bf16 v[52:55], a[188:191], v[116:119], v[52:55]
    v_mfma_f32_16x16x32_bf16 v[56:59], a[192:195], v[116:119], v[56:59]
    s_waitcnt vmcnt(33)
    s_waitcnt lgkmcnt(0)
    v_mfma_f32_16x16x32_bf16 v[48:51], a[196:199], v[120:123], v[48:51]
    ds_read2_b64 v[116:119], v34 offset0:96 offset1:100
    v_mfma_f32_16x16x32_bf16 v[52:55], a[200:203], v[120:123], v[52:55]
    v_mfma_f32_16x16x32_bf16 v[56:59], a[204:207], v[120:123], v[56:59]
    s_waitcnt vmcnt(30)
    s_waitcnt lgkmcnt(0)
    v_mfma_f32_16x16x32_bf16 v[48:51], a[208:211], v[116:119], v[48:51]
    ds_read2_b64 v[120:123], v34 offset0:104 offset1:108
    v_mfma_f32_16x16x32_bf16 v[52:55], a[212:215], v[116:119], v[52:55]
    v_mfma_f32_16x16x32_bf16 v[56:59], a[216:219], v[116:119], v[56:59]
    s_waitcnt vmcnt(27)
    s_waitcnt lgkmcnt(0)
    v_mfma_f32_16x16x32_bf16 v[48:51], a[220:223], v[120:123], v[48:51]
    ds_read2_b64 v[116:119], v34 offset0:112 offset1:116
    v_mfma_f32_16x16x32_bf16 v[52:55], a[224:227], v[120:123], v[52:55]
    v_mfma_f32_16x16x32_bf16 v[56:59], a[228:231], v[120:123], v[56:59]
    s_waitcnt vmcnt(24)
    s_waitcnt lgkmcnt(0)
    v_mfma_f32_16x16x32_bf16 v[48:51], a[232:235], v[116:119], v[48:51]
    ds_read2_b64 v[120:123], v34 offset0:120 offset1:124
    v_mfma_f32_16x16x32_bf16 v[52:55], a[236:239], v[116:119], v[52:55]
    v_mfma_f32_16x16x32_bf16 v[56:59], a[240:243], v[116:119], v[56:59]
    s_waitcnt vmcnt(21)
    s_waitcnt lgkmcnt(0)
    v_mfma_f32_16x16x32_bf16 v[48:51], a[244:247], v[120:123], v[48:51]
    v_mfma_f32_16x16x32_bf16 v[52:55], a[248:251], v[120:123], v[52:55]
    v_mfma_f32_16x16x32_bf16 v[56:59], a[252:255], v[120:123], v[56:59]
    s_nop 5
    v_mov_b32_dpp v36, v48 quad_perm:[0,0,2,2] row_mask:0xf bank_mask:0xf
    v_mov_b32_dpp v48, v48 quad_perm:[1,1,3,3] row_mask:0xf bank_mask:0xf
    v_mov_b32_dpp v37, v49 quad_perm:[0,0,2,2] row_mask:0xf bank_mask:0xf
    v_mov_b32_dpp v49, v49 quad_perm:[1,1,3,3] row_mask:0xf bank_mask:0xf
    v_mov_b32_dpp v38, v50 quad_perm:[0,0,2,2] row_mask:0xf bank_mask:0xf
    v_mov_b32_dpp v50, v50 quad_perm:[1,1,3,3] row_mask:0xf bank_mask:0xf
    v_mov_b32_dpp v39, v51 quad_perm:[0,0,2,2] row_mask:0xf bank_mask:0xf
    v_mov_b32_dpp v51, v51 quad_perm:[1,1,3,3] row_mask:0xf bank_mask:0xf
    v_mov_b32_dpp v40, v52 quad_perm:[0,0,2,2] row_mask:0xf bank_mask:0xf
    v_mov_b32_dpp v52, v52 quad_perm:[1,1,3,3] row_mask:0xf bank_mask:0xf
    v_mov_b32_dpp v41, v53 quad_perm:[0,0,2,2] row_mask:0xf bank_mask:0xf
    v_mov_b32_dpp v53, v53 quad_perm:[1,1,3,3] row_mask:0xf bank_mask:0xf
    v_mov_b32_dpp v42, v54 quad_perm:[0,0,2,2] row_mask:0xf bank_mask:0xf
    v_mov_b32_dpp v54, v54 quad_perm:[1,1,3,3] row_mask:0xf bank_mask:0xf
    v_mov_b32_dpp v43, v55 quad_perm:[0,0,2,2] row_mask:0xf bank_mask:0xf
    v_mov_b32_dpp v55, v55 quad_perm:[1,1,3,3] row_mask:0xf bank_mask:0xf
    v_mov_b32_dpp v44, v56 quad_perm:[0,0,2,2] row_mask:0xf bank_mask:0xf
    v_mov_b32_dpp v56, v56 quad_perm:[1,1,3,3] row_mask:0xf bank_mask:0xf
    v_mov_b32_dpp v45, v57 quad_perm:[0,0,2,2] row_mask:0xf bank_mask:0xf
    v_mov_b32_dpp v57, v57 quad_perm:[1,1,3,3] row_mask:0xf bank_mask:0xf
    v_mov_b32_dpp v46, v58 quad_perm:[0,0,2,2] row_mask:0xf bank_mask:0xf
    v_mov_b32_dpp v58, v58 quad_perm:[1,1,3,3] row_mask:0xf bank_mask:0xf
    v_mov_b32_dpp v47, v59 quad_perm:[0,0,2,2] row_mask:0xf bank_mask:0xf
    v_mov_b32_dpp v59, v59 quad_perm:[1,1,3,3] row_mask:0xf bank_mask:0xf
    ds_read_b128 v[140:143], v35 offset:2048
    s_xor_b32 s66, s3, 3
    s_mul_i32 s66, s66, 6144
    s_add_u32 s66, s66, 65536
    v_add_u32 v8, s66, v3
    s_xor_b32 s66, s3, 1
    s_mul_i32 s66, s66, 6144
    s_add_u32 s66, s66, 67584
    v_add_u32 v9, s66, v3
    s_xor_b32 s66, s3, 2
    s_mul_i32 s66, s66, 6144
    s_add_u32 s66, s66, 69632
    v_add_u32 v10, s66, v3
    s_lshr_b32 s66, s44, 3
    s_and_b32 s67, s44, 1
    s_lshl1_add_u32 s66, s66, s67
    s_and_b32 s67, s3, 1
    s_lshl1_add_u32 s66, s66, s67
    s_bfe_u32 s67, s44, 0x20001
    s_lshl4_add_u32 s66, s66, s67
    s_lshl_b32 s66, s66, 12
    s_lshr_b32 s67, s3, 1
    s_lshl1_add_u32 s67, s45, s67
    s_lshl_b32 s67, s67, 6
    s_add_u32 s66, s66, s67
    v_and_b32 v2, 12, v1
    v_lshlrev_b32 v2, 12, v2
    v_and_b32 v11, 3, v1
    v_lshl_add_u32 v2, v11, 10, v2
    v_and_b32 v11, 48, v1
    v_add3_u32 v2, v2, v11, s66
    s_waitcnt lgkmcnt(0)
    v_lshlrev_b32 v116, 16, v140
    v_and_b32 v117, 0xffff0000, v140
    v_lshlrev_b32 v118, 16, v141
    v_and_b32 v119, 0xffff0000, v141
    v_lshlrev_b32 v120, 16, v142
    v_and_b32 v121, 0xffff0000, v142
    v_lshlrev_b32 v122, 16, v143
    v_and_b32 v123, 0xffff0000, v143
    s_waitcnt vmcnt(13)
    v_max3_u32 v11, v216, v220, v224
    v_max3_u32 v11, v11, v228, v232
    v_max3_u32 v11, v11, v236, v240
    v_max_u32 v11, v11, v244
    v_cmp_eq_u32 vcc, -1, v11
    s_cbranch_vccnz L_retry_7
L_back_8:
    ds_write_b128 v18, v[216:219] offset:0
    ds_write_b128 v18, v[220:223] offset:4096
    ds_write_b128 v18, v[224:227] offset:8192
    ds_write_b128 v18, v[228:231] offset:12288
    ds_write_b128 v18, v[232:235] offset:16384
    ds_write_b128 v18, v[236:239] offset:20480
    ds_write_b128 v18, v[240:243] offset:24576
    ds_write_b128 v18, v[244:247] offset:28672
    s_waitcnt lgkmcnt(0)
    s_barrier
    ds_read_b64_tr_b16 v[84:85], v28 offset:0
    ds_read_b64_tr_b16 v[86:87], v28 offset:1024
    ds_read_b64_tr_b16 v[88:89], v29 offset:0
    ds_read_b64_tr_b16 v[90:91], v29 offset:1024
    ds_read_b64_tr_b16 v[140:141], v30 offset:0
    ds_read_b64_tr_b16 v[142:143], v30 offset:256
    ds_read_b64_tr_b16 v[92:93], v28 offset:2048
    ds_read_b64_tr_b16 v[94:95], v28 offset:3072
    ds_read_b64_tr_b16 v[96:97], v29 offset:2048
    ds_read_b64_tr_b16 v[98:99], v29 offset:3072
    s_waitcnt lgkmcnt(4)
    v_lshlrev_b32 v100, 16, v140
    v_and_b32 v101, 0xffff0000, v140
    v_lshlrev_b32 v102, 16, v141
    v_and_b32 v103, 0xffff0000, v141
    v_lshlrev_b32 v104, 16, v142
    v_and_b32 v105, 0xffff0000, v142
    v_lshlrev_b32 v106, 16, v143
    v_and_b32 v107, 0xffff0000, v143
    v_mul_f32 v100, v100, v20
    v_mul_f32 v101, v101, v21
    v_mul_f32 v102, v102, v22
    v_mul_f32 v103, v103, v23
    v_mul_f32 v104, v104, v24
    v_mul_f32 v105, v105, v25
    v_mul_f32 v106, v106, v26
    v_mul_f32 v107, v107, v27
    v_add_f32 v140, v100, v101
    v_mul_f32 v141, v100, v100
    v_fmac_f32 v141, v101, v101
    v_add_f32 v140, v140, v102
    v_fmac_f32 v141, v102, v102
    v_add_f32 v140, v140, v103
    v_fmac_f32 v141, v103, v103
    v_add_f32 v140, v140, v104
    v_fmac_f32 v141, v104, v104
    v_add_f32 v140, v140, v105
    v_fmac_f32 v141, v105, v105
    v_add_f32 v140, v140, v106
    v_fmac_f32 v141, v106, v106
    v_add_f32 v140, v140, v107
    v_fmac_f32 v141, v107, v107
    s_nop 1
    v_permlane32_swap_b32 v140, v141
    v_add_f32 v140, v140, v141
    v_mov_b32 v141, v140
    s_nop 1
    v_permlane16_swap_b32 v140, v141
    v_add_f32 v140, v140, v141
    v_mov_b32 v141, v140
    s_nop 1
    v_permlane32_swap_b32 v140, v141
    s_mov_b64 exec, 0xffff
    s_cmp_lg_u32 s63, 0
    s_cbranch_scc1 L_far_9
    buffer_store_dwordx2 v[140:141], v19, s[32:35], s23 offen
L_near_10:
    s_mov_b64 exec, -1
    s_add_u32 s23, s23, 4096
    v_mfma_f32_16x16x32_bf16 v[60:63], a[64:67], v[84:87], 0
    ds_read_b64_tr_b16 v[248:249], v28 offset:4096
    buffer_load_dwordx4 v[216:219], v17, s[32:35], 0 offen sc1
    v_mfma_f32_16x16x32_bf16 v[68:71], a[68:71], v[84:87], 0
    ds_read_b64_tr_b16 v[250:251], v28 offset:5120
    v_mfma_f32_16x16x32_bf16 v[76:79], a[72:75], v[84:87], 0
    ds_read_b64_tr_b16 v[252:253], v29 offset:4096
    buffer_load_dwordx4 v[220:223], v17, s[32:35], s49 offen sc1
    v_mfma_f32_16x16x32_bf16 v[64:67], a[64:67], v[88:91], 0
    ds_read_b64_tr_b16 v[254:255], v29 offset:5120
    v_mfma_f32_16x16x32_bf16 v[72:75], a[68:71], v[88:91], 0
    v_mfma_f32_16x16x32_bf16 v[80:83], a[72:75], v[88:91], 0
    buffer_load_dwordx4 v[224:227], v17, s[32:35], s50 offen sc1
    s_waitcnt lgkmcnt(4)
    v_mfma_f32_16x16x32_bf16 v[60:63], a[76:79], v[92:95], v[60:63]
    ds_read_b64_tr_b16 v[84:85], v28 offset:6144
    v_mfma_f32_16x16x32_bf16 v[68:71], a[80:83], v[92:95], v[68:71]
    ds_read_b64_tr_b16 v[86:87], v28 offset:7168
    v_mfma_f32_16x16x32_bf16 v[76:79], a[84:87], v[92:95], v[76:79]
    ds_read_b64_tr_b16 v[88:89], v29 offset:6144
    buffer_load_dwordx4 v[228:231], v17, s[32:35], s51 offen sc1
    v_mfma_f32_16x16x32_bf16 v[64:67], a[76:79], v[96:99], v[64:67]
    ds_read_b64_tr_b16 v[90:91], v29 offset:7168
    v_mfma_f32_16x16x32_bf16 v[72:75], a[80:83], v[96:99], v[72:75]
    v_mfma_f32_16x16x32_bf16 v[80:83], a[84:87], v[96:99], v[80:83]
    buffer_load_dwordx4 v[232:235], v17, s[32:35], s52 offen sc1
    s_waitcnt lgkmcnt(4)
    v_mfma_f32_16x16x32_bf16 v[60:63], a[88:91], v[248:251], v[60:63]
    ds_read_b64_tr_b16 v[92:93], v28 offset:8192
    v_mfma_f32_16x16x32_bf16 v[68:71], a[92:95], v[248:251], v[68:71]
    ds_read_b64_tr_b16 v[94:95], v28 offset:9216
    v_mfma_f32_16x16x32_bf16 v[76:79], a[96:99], v[248:251], v[76:79]
    ds_read_b64_tr_b16 v[96:97], v29 offset:8192
    buffer_load_dwordx4 v[236:239], v17, s[32:35], s53 offen sc1
    v_mfma_f32_16x16x32_bf16 v[64:67], a[88:91], v[252:255], v[64:67]
    ds_read_b64_tr_b16 v[98:99], v29 offset:9216
    v_mfma_f32_16x16x32_bf16 v[72:75], a[92:95], v[252:255], v[72:75]
    v_mfma_f32_16x16x32_bf16 v[80:83], a[96:99], v[252:255], v[80:83]
    buffer_load_dwordx4 v[240:243], v17, s[32:35], s54 offen sc1
    s_waitcnt lgkmcnt(4)
    v_mfma_f32_16x16x32_bf16 v[60:63], a[100:103], v[84:87], v[60:63]
    ds_read_b64_tr_b16 v[248:249], v28 offset:10240
    v_mfma_f32_16x16x32_bf16 v[68:71], a[104:107], v[84:87], v[68:71]
    ds_read_b64_tr_b16 v[250:251], v28 offset:11264
    v_mfma_f32_16x16x32_bf16 v[76:79], a[108:111], v[84:87], v[76:79]
    ds_read_b64_tr_b16 v[252:253], v29 offset:10240
    buffer_load_dwordx4 v[244:247], v17, s[32:35], s55 offen sc1
    v_mfma_f32_16x16x32_bf16 v[64:67], a[100:103], v[88:91], v[64:67]
    ds_read_b64_tr_b16 v[254:255], v29 offset:11264
    v_mfma_f32_16x16x32_bf16 v[72:75], a[104:107], v[88:91], v[72:75]
    v_mfma_f32_16x16x32_bf16 v[80:83], a[108:111], v[88:91], v[80:83]
    buffer_load_dwordx4 a[40:43], v4, s[32:35], s53 offen offset:0 sc1
    s_waitcnt lgkmcnt(4)
    v_mfma_f32_16x16x32_bf16 v[60:63], a[112:115], v[92:95], v[60:63]
    ds_read_b64_tr_b16 v[84:85], v28 offset:12288
    v_mfma_f32_16x16x32_bf16 v[68:71], a[116:119], v[92:95], v[68:71]
    ds_read_b64_tr_b16 v[86:87], v28 offset:13312
    v_mfma_f32_16x16x32_bf16 v[76:79], a[120:123], v[92:95], v[76:79]
    ds_read_b64_tr_b16 v[88:89], v29 offset:12288
    buffer_load_dwordx4 a[44:47], v4, s[32:35], s53 offen offset:1024 sc1
    v_mfma_f32_16x16x32_bf16 v[64:67], a[112:115], v[96:99], v[64:67]
    ds_read_b64_tr_b16 v[90:91], v29 offset:13312
    v_mfma_f32_16x16x32_bf16 v[72:75], a[116:119], v[96:99], v[72:75]
    v_mfma_f32_16x16x32_bf16 v[80:83], a[120:123], v[96:99], v[80:83]
    buffer_load_dwordx4 a[48:51], v4, s[32:35], s54 offen offset:0 sc1
    s_waitcnt lgkmcnt(4)
    v_mfma_f32_16x16x32_bf16 v[60:63], a[124:127], v[248:251], v[60:63]
    ds_read_b64_tr_b16 v[92:93], v28 offset:14336
    v_mfma_f32_16x16x32_bf16 v[68:71], a[128:131], v[248:251], v[68:71]
    ds_read_b64_tr_b16 v[94:95], v28 offset:15360
    v_mfma_f32_16x16x32_bf16 v[76:79], a[132:135], v[248:251], v[76:79]
    ds_read_b64_tr_b16 v[96:97], v29 offset:14336
    buffer_load_dwordx4 a[52:55], v4, s[32:35], s54 offen offset:1024 sc1
    v_mfma_f32_16x16x32_bf16 v[64:67], a[124:127], v[252:255], v[64:67]
    ds_read_b64_tr_b16 v[98:99], v29 offset:15360
    v_mfma_f32_16x16x32_bf16 v[72:75], a[128:131], v[252:255], v[72:75]
    v_mfma_f32_16x16x32_bf16 v[80:83], a[132:135], v[252:255], v[80:83]
    buffer_load_dwordx4 a[56:59], v4, s[32:35], s55 offen offset:0 sc1
    s_waitcnt lgkmcnt(4)
    v_mfma_f32_16x16x32_bf16 v[60:63], a[136:139], v[84:87], v[60:63]
    ds_read_b64_tr_b16 v[248:249], v28 offset:16384
    v_mfma_f32_16x16x32_bf16 v[68:71], a[140:143], v[84:87], v[68:71]
    ds_read_b64_tr_b16 v[250:251], v28 offset:17408
    v_mfma_f32_16x16x32_bf16 v[76:79], a[144:147], v[84:87], v[76:79]
    ds_read_b64_tr_b16 v[252:253], v29 offset:16384
    buffer_load_dwordx4 a[60:63], v4, s[32:35], s55 offen offset:1024 sc1
    v_mfma_f32_16x16x32_bf16 v[64:67], a[136:139], v[88:91], v[64:67]
    ds_read_b64_tr_b16 v[254:255], v29 offset:17408
    v_mfma_f32_16x16x32_bf16 v[72:75], a[140:143], v[88:91], v[72:75]
    v_mfma_f32_16x16x32_bf16 v[80:83], a[144:147], v[88:91], v[80:83]
    buffer_load_dwordx4 v[144:147], v4, s[32:35], s56 offen offset:0 sc1
    s_waitcnt lgkmcnt(4)
    v_mfma_f32_16x16x32_bf16 v[60:63], a[148:151], v[92:95], v[60:63]
    ds_read_b64_tr_b16 v[84:85], v28 offset:18432
    v_mfma_f32_16x16x32_bf16 v[68:71], a[152:155], v[92:95], v[68:71]
    ds_read_b64_tr_b16 v[86:87], v28 offset:19456
    v_mfma_f32_16x16x32_bf16 v[76:79], a[156:159], v[92:95], v[76:79]
    ds_read_b64_tr_b16 v[88:89], v29 offset:18432
    v_mfma_f32_16x16x32_bf16 v[64:67], a[148:151], v[96:99], v[64:67]
    ds_read_b64_tr_b16 v[90:91], v29 offset:19456
    buffer_load_dwordx4 v[124:127], v3, s[32:35], s24 offen offset:0 sc1
    v_mfma_f32_16x16x32_bf16 v[72:75], a[152:155], v[96:99], v[72:75]
    v_mfma_f32_16x16x32_bf16 v[80:83], a[156:159], v[96:99], v[80:83]
    buffer_load_dwordx4 v[128:131], v3, s[32:35], s24 offen offset:1024 sc1
    s_waitcnt lgkmcnt(4)
    v_mfma_f32_16x16x32_bf16 v[60:63], a[160:163], v[248:251], v[60:63]
    ds_read_b64_tr_b16 v[92:93], v28 offset:20480
    v_mfma_f32_16x16x32_bf16 v[68:71], a[164:167], v[248:251], v[68:71]
    ds_read_b64_tr_b16 v[94:95], v28 offset:21504
    v_mfma_f32_16x16x32_bf16 v[76:79], a[168:171], v[248:251], v[76:79]
    ds_read_b64_tr_b16 v[96:97], v29 offset:20480
    buffer_load_dwordx4 v[132:135], v3, s[32:35], s24 offen offset:2048 sc1
    v_mfma_f32_16x16x32_bf16 v[64:67], a[160:163], v[252:255], v[64:67]
    ds_read_b64_tr_b16 v[98:99], v29 offset:21504
    v_mfma_f32_16x16x32_bf16 v[72:75], a[164:167], v[252:255], v[72:75]
    v_mfma_f32_16x16x32_bf16 v[80:83], a[168:171], v[252:255], v[80:83]
    buffer_load_dwordx4 v[136:139], v3, s[32:35], s24 offen offset:3072 sc1
    s_waitcnt lgkmcnt(4)
    v_mfma_f32_16x16x32_bf16 v[60:63], a[172:175], v[84:87], v[60:63]
    ds_read_b64_tr_b16 v[248:249], v28 offset:22528
    v_mfma_f32_16x16x32_bf16 v[68:71], a[176:179], v[84:87], v[68:71]
    ds_read_b64_tr_b16 v[250:251], v28 offset:23552
    v_mfma_f32_16x16x32_bf16 v[76:79], a[180:183], v[84:87], v[76:79]
    ds_read_b64_tr_b16 v[252:253], v29 offset:22528
    buffer_load_dwordx4 v[148:151], v4, s[32:35], s56 offen offset:1024 sc1
    v_mfma_f32_16x16x32_bf16 v[64:67], a[172:175], v[88:91], v[64:67]
    ds_read_b64_tr_b16 v[254:255], v29 offset:23552
    s_waitcnt vmcnt(12)
    v_max3_u32 v11, v216, v220, v224
    v_max3_u32 v11, v11, v228, v232
    v_max3_u32 v11, v11, v236, v240
    v_max_u32 v11, v11, v244
    v_cmp_eq_u32 vcc, -1, v11
    s_cbranch_vccnz L_retry_11
L_back_12:
    v_mfma_f32_16x16x32_bf16 v[72:75], a[176:179], v[88:91], v[72:75]
    ds_write_b128 v18, v[216:219] offset:32768
    ds_write_b128 v18, v[220:223] offset:36864
    v_mfma_f32_16x16x32_bf16 v[80:83], a[180:183], v[88:91], v[80:83]
    buffer_load_dwordx4 v[152:155], v4, s[32:35], s57 offen offset:0 sc1
    s_waitcnt lgkmcnt(6)
    v_mfma_f32_16x16x32_bf16 v[60:63], a[184:187], v[92:95], v[60:63]
    ds_read_b64_tr_b16 v[84:85], v28 offset:24576
    ds_write_b128 v18, v[224:227] offset:40960
    v_mfma_f32_16x16x32_bf16 v[68:71], a[188:191], v[92:95], v[68:71]
    ds_read_b64_tr_b16 v[86:87], v28 offset:25600
    ds_write_b128 v18, v[228:231] offset:45056
    v_mfma_f32_16x16x32_bf16 v[76:79], a[192:195], v[92:95], v[76:79]
    ds_read_b64_tr_b16 v[88:89], v29 offset:24576
    buffer_load_dwordx4 v[156:159], v4, s[32:35], s57 offen offset:1024 sc1
    v_mfma_f32_16x16x32_bf16 v[64:67], a[184:187], v[96:99], v[64:67]
    ds_read_b64_tr_b16 v[90:91], v29 offset:25600
    ds_write_b128 v18, v[232:235] offset:49152
    v_mfma_f32_16x16x32_bf16 v[72:75], a[188:191], v[96:99], v[72:75]
    ds_write_b128 v18, v[236:239] offset:53248
    ds_write_b128 v18, v[240:243] offset:57344
    v_mfma_f32_16x16x32_bf16 v[80:83], a[192:195], v[96:99], v[80:83]
    buffer_load_dwordx4 v[160:163], v4, s[32:35], s18 offen offset:0 sc1
    s_waitcnt lgkmcnt(11)
    v_mfma_f32_16x16x32_bf16 v[60:63], a[196:199], v[248:251], v[60:63]
    ds_read_b64_tr_b16 v[92:93], v28 offset:26624
    ds_write_b128 v18, v[244:247] offset:61440
    v_mfma_f32_16x16x32_bf16 v[68:71], a[200:203], v[248:251], v[68:71]
    ds_read_b64_tr_b16 v[94:95], v28 offset:27648
    s_waitcnt vmcnt(4)
    v_max3_u32 v11, v124, v126, v128
    v_max3_u32 v11, v11, v130, v132
    v_max3_u32 v11, v11, v134, v136
    v_max_u32 v11, v11, v138
    v_cmp_eq_u32 vcc, -1, v11
    s_cbranch_vccnz L_retry_13
L_back_14:
    v_mfma_f32_16x16x32_bf16 v[76:79], a[204:207], v[248:251], v[76:79]
    ds_read_b64_tr_b16 v[96:97], v29 offset:26624
    buffer_load_dwordx4 v[164:167], v4, s[32:35], s18 offen offset:1024 sc1
    v_mfma_f32_16x16x32_bf16 v[64:67], a[196:199], v[252:255], v[64:67]
    ds_read_b64_tr_b16 v[98:99], v29 offset:27648
    v_add_f32 v124, v124, v132
    v_mfma_f32_16x16x32_bf16 v[72:75], a[200:203], v[252:255], v[72:75]
    v_add_f32 v125, v125, v133
    v_add_f32 v126, v126, v134
    v_mfma_f32_16x16x32_bf16 v[80:83], a[204:207], v[252:255], v[80:83]
    buffer_load_dwordx4 v[168:171], v5, s[32:35], 0 offen offset:0 sc1
    s_waitcnt lgkmcnt(8)
    v_mfma_f32_16x16x32_bf16 v[60:63], a[208:211], v[84:87], v[60:63]
    ds_read_b64_tr_b16 v[248:249], v28 offset:28672
    v_add_f32 v127, v127, v135
    v_mfma_f32_16x16x32_bf16 v[68:71], a[212:215], v[84:87], v[68:71]
    ds_read_b64_tr_b16 v[250:251], v28 offset:29696
    v_add_f32 v128, v128, v136
    v_mfma_f32_16x16x32_bf16 v[76:79], a[216:219], v[84:87], v[76:79]
    ds_read_b64_tr_b16 v[252:253], v29 offset:28672
    buffer_load_dwordx4 v[172:175], v5, s[32:35], 0 offen offset:1024 sc1
    v_mfma_f32_16x16x32_bf16 v[64:67], a[208:211], v[88:91], v[64:67]
    ds_read_b64_tr_b16 v[254:255], v29 offset:29696
    v_add_f32 v129, v129, v137
    v_mfma_f32_16x16x32_bf16 v[72:75], a[212:215], v[88:91], v[72:75]
    v_add_f32 v130, v130, v138
    v_add_f32 v131, v131, v139
    v_mfma_f32_16x16x32_bf16 v[80:83], a[216:219], v[88:91], v[80:83]
    buffer_load_dwordx4 v[176:179], v5, s[32:35], s49 offen offset:0 sc1
    s_waitcnt lgkmcnt(4)
    v_mfma_f32_16x16x32_bf16 v[60:63], a[220:223], v[92:95], v[60:63]
    ds_read_b64_tr_b16 v[84:85], v28 offset:30720
    v_add_f32 v124, v124, v128
    v_mfma_f32_16x16x32_bf16 v[68:71], a[224:227], v[92:95], v[68:71]
    ds_read_b64_tr_b16 v[86:87], v28 offset:31744
    v_add_f32 v125, v125, v129
    v_mfma_f32_16x16x32_bf16 v[76:79], a[228:231], v[92:95], v[76:79]
    ds_read_b64_tr_b16 v[88:89], v29 offset:30720
    buffer_load_dwordx4 v[180:183], v5, s[32:35], s49 offen offset:1024 sc1
    v_mfma_f32_16x16x32_bf16 v[64:67], a[220:223], v[96:99], v[64:67]
    ds_read_b64_tr_b16 v[90:91], v29 offset:31744
    v_add_f32 v126, v126, v130
    v_mfma_f32_16x16x32_bf16 v[72:75], a[224:227], v[96:99], v[72:75]
    v_add_f32 v127, v127, v131
    v_permlane32_swap_b32 v124, v126
    v_mfma_f32_16x16x32_bf16 v[80:83], a[228:231], v[96:99], v[80:83]
    buffer_load_dwordx4 v[184:187], v5, s[32:35], s50 offen offset:0 sc1
    s_waitcnt lgkmcnt(4)
    v_mfma_f32_16x16x32_bf16 v[60:63], a[232:235], v[248:251], v[60:63]
    v_permlane32_swap_b32 v125, v127
    v_add_f32 v124, v124, v126
    v_mfma_f32_16x16x32_bf16 v[68:71], a[236:239], v[248:251], v[68:71]
    v_add_f32 v125, v125, v127
    s_nop 1
    v_permlane16_swap_b32 v124, v125
    v_mfma_f32_16x16x32_bf16 v[76:79], a[240:243], v[248:251], v[76:79]
    buffer_load_dwordx4 v[188:191], v5, s[32:35], s50 offen offset:1024 sc1
    v_add_f32 v124, v124, v125
    v_mfma_f32_16x16x32_bf16 v[64:67], a[232:235], v[252:255], v[64:67]
    v_mul_f32 v124, 0x3b000000, v124
    v_mov_b32 v125, v124
    v_mfma_f32_16x16x32_bf16 v[72:75], a[236:239], v[252:255], v[72:75]
    s_nop 0
    v_permlane16_swap_b32 v124, v125
    v_fma_f32 v125, -v124, v124, v125
    v_mfma_f32_16x16x32_bf16 v[80:83], a[240:243], v[252:255], v[80:83]
    buffer_load_dwordx4 v[192:195], v5, s[32:35], s51 offen offset:0 sc1
    s_waitcnt lgkmcnt(0)
    v_mfma_f32_16x16x32_bf16 v[60:63], a[244:247], v[84:87], v[60:63]
    v_max_f32 v125, 0, v125
    v_cvt_pk_bf16_f32 v125, v125, v124
    v_mfma_f32_16x16x32_bf16 v[68:71], a[248:251], v[84:87], v[68:71]
    v_and_b32 v124, 0xffff0000, v125
    v_and_b32 v126, 0xffff0000, v125
    v_mfma_f32_16x16x32_bf16 v[76:79], a[252:255], v[84:87], v[76:79]
    buffer_load_dwordx4 v[196:199], v5, s[32:35], s51 offen offset:1024 sc1
    v_lshlrev_b32 v125, 16, v125
    v_mfma_f32_16x16x32_bf16 v[64:67], a[244:247], v[88:91], v[64:67]
    v_add_f32 v125, 0x3727c5ac, v125
    v_cvt_pk_bf16_f32 v125, v125, v125
    v_mfma_f32_16x16x32_bf16 v[72:75], a[248:251], v[88:91], v[72:75]
    v_permlane32_swap_b32 v124, v126
    v_lshlrev_b32 v125, 16, v125
    v_mfma_f32_16x16x32_bf16 v[80:83], a[252:255], v[88:91], v[80:83]
    buffer_load_dwordx4 v[200:203], v5, s[32:35], s52 offen offset:0 sc1
    v_sqrt_f32 v125, v125
    s_nop 0
    v_cvt_pk_bf16_f32 v125, v125, v125
    v_lshlrev_b32 v125, 16, v125
    v_rcp_f32 v127, v125
    v_rcp_f32 v125, v125
    s_nop 1
    v_permlane32_swap_b32 v125, v127
    s_barrier
    ds_read_b64_tr_b16 v[92:93], v28 offset:32768
    ds_read_b64_tr_b16 v[94:95], v28 offset:33792
    ds_read_b64_tr_b16 v[96:97], v29 offset:32768
    ds_read_b64_tr_b16 v[98:99], v29 offset:33792
    ds_read_b64_tr_b16 v[140:141], v30 offset:32768
    ds_read_b64_tr_b16 v[142:143], v30 offset:33024
    ds_read_b64_tr_b16 v[248:249], v28 offset:34816
    ds_read_b64_tr_b16 v[250:251], v28 offset:35840
    ds_read_b64_tr_b16 v[252:253], v29 offset:34816
    ds_read_b64_tr_b16 v[254:255], v29 offset:35840
    v_pk_fma_f32 v[60:61], v[36:37], v[124:125], v[60:61] op_sel:[0,0,0] op_sel_hi:[1,0,1] neg_lo:[0,1,0] neg_hi:[0,1,0]
    v_pk_fma_f32 v[62:63], v[38:39], v[124:125], v[62:63] op_sel:[0,0,0] op_sel_hi:[1,0,1] neg_lo:[0,1,0] neg_hi:[0,1,0]
    v_pk_fma_f32 v[64:65], v[36:37], v[126:127], v[64:65] op_sel:[0,0,0] op_sel_hi:[1,0,1] neg_lo:[0,1,0] neg_hi:[0,1,0]
    v_pk_fma_f32 v[66:67], v[38:39], v[126:127], v[66:67] op_sel:[0,0,0] op_sel_hi:[1,0,1] neg_lo:[0,1,0] neg_hi:[0,1,0]
    v_pk_fma_f32 v[60:61], v[60:61], v[124:125], v[48:49] op_sel:[0,1,0] op_sel_hi:[1,1,1]
    v_pk_fma_f32 v[62:63], v[62:63], v[124:125], v[50:51] op_sel:[0,1,0] op_sel_hi:[1,1,1]
    v_pk_fma_f32 v[64:65], v[64:65], v[126:127], v[48:49] op_sel:[0,1,0] op_sel_hi:[1,1,1]
    v_pk_fma_f32 v[66:67], v[66:67], v[126:127], v[50:51] op_sel:[0,1,0] op_sel_hi:[1,1,1]
    v_cvt_pk_bf16_f32 v128, v60, v61
    v_cvt_pk_bf16_f32 v129, v62, v63
    v_cvt_pk_bf16_f32 v130, v64, v65
    v_cvt_pk_bf16_f32 v131, v66, v67
    v_pk_max_i16 v128, v128, 0
    v_pk_max_i16 v130, v130, 0
    v_pk_max_i16 v129, v129, 0
    v_pk_max_i16 v131, v131, 0
    v_pk_fma_f32 v[68:69], v[40:41], v[124:125], v[68:69] op_sel:[0,0,0] op_sel_hi:[1,0,1] neg_lo:[0,1,0] neg_hi:[0,1,0]
    v_pk_fma_f32 v[70:71], v[42:43], v[124:125], v[70:71] op_sel:[0,0,0] op_sel_hi:[1,0,1] neg_lo:[0,1,0] neg_hi:[0,1,0]
    buffer_load_dwordx4 v[204:207], v5, s[32:35], s52 offen offset:1024 sc1
    v_permlane32_swap_b32 v128, v130
    v_permlane32_swap_b32 v129, v131
    s_cmp_lg_u32 s63, 0
    s_cbranch_scc1 L_far_15
    buffer_store_dwordx4 v[128:131], v12, s[32:35], s20 offen
L_near_16:
    v_pk_fma_f32 v[72:73], v[40:41], v[126:127], v[72:73] op_sel:[0,0,0] op_sel_hi:[1,0,1] neg_lo:[0,1,0] neg_hi:[0,1,0]
    v_pk_fma_f32 v[74:75], v[42:43], v[126:127], v[74:75] op_sel:[0,0,0] op_sel_hi:[1,0,1] neg_lo:[0,1,0] neg_hi:[0,1,0]
    v_pk_fma_f32 v[68:69], v[68:69], v[124:125], v[52:53] op_sel:[0,1,0] op_sel_hi:[1,1,1]
    v_pk_fma_f32 v[70:71], v[70:71], v[124:125], v[54:55] op_sel:[0,1,0] op_sel_hi:[1,1,1]
    v_pk_fma_f32 v[72:73], v[72:73], v[126:127], v[52:53] op_sel:[0,1,0] op_sel_hi:[1,1,1]
    v_pk_fma_f32 v[74:75], v[74:75], v[126:127], v[54:55] op_sel:[0,1,0] op_sel_hi:[1,1,1]
    v_cvt_pk_bf16_f32 v132, v68, v69
    v_cvt_pk_bf16_f32 v133, v70, v71
    v_cvt_pk_bf16_f32 v134, v72, v73
    v_cvt_pk_bf16_f32 v135, v74, v75
    v_pk_max_i16 v132, v132, 0
    v_pk_max_i16 v134, v134, 0
    v_pk_max_i16 v133, v133, 0
    v_pk_max_i16 v135, v135, 0
    v_pk_fma_f32 v[76:77], v[44:45], v[124:125], v[76:77] op_sel:[0,0,0] op_sel_hi:[1,0,1] neg_lo:[0,1,0] neg_hi:[0,1,0]
    v_pk_fma_f32 v[78:79], v[46:47], v[124:125], v[78:79] op_sel:[0,0,0] op_sel_hi:[1,0,1] neg_lo:[0,1,0] neg_hi:[0,1,0]
    v_permlane32_swap_b32 v132, v134
    v_permlane32_swap_b32 v133, v135
    s_cmp_lg_u32 s63, 0
    s_cbranch_scc1 L_far_17
    buffer_store_dwordx4 v[132:135], v13, s[32:35], s20 offen
L_near_18:
    v_pk_fma_f32 v[80:81], v[44:45], v[126:127], v[80:81] op_sel:[0,0,0] op_sel_hi:[1,0,1] neg_lo:[0,1,0] neg_hi:[0,1,0]
    v_pk_fma_f32 v[82:83], v[46:47], v[126:127], v[82:83] op_sel:[0,0,0] op_sel_hi:[1,0,1] neg_lo:[0,1,0] neg_hi:[0,1,0]
    buffer_load_dwordx4 v[208:211], v5, s[32:35], s53 offen offset:0 sc1
    v_pk_fma_f32 v[76:77], v[76:77], v[124:125], v[56:57] op_sel:[0,1,0] op_sel_hi:[1,1,1]
    v_pk_fma_f32 v[78:79], v[78:79], v[124:125], v[58:59] op_sel:[0,1,0] op_sel_hi:[1,1,1]
    v_pk_fma_f32 v[80:81], v[80:81], v[126:127], v[56:57] op_sel:[0,1,0] op_sel_hi:[1,1,1]
    v_pk_fma_f32 v[82:83], v[82:83], v[126:127], v[58:59] op_sel:[0,1,0] op_sel_hi:[1,1,1]
    v_cvt_pk_bf16_f32 v136, v76, v77
    v_cvt_pk_bf16_f32 v137, v78, v79
    v_cvt_pk_bf16_f32 v138, v80, v81
    v_cvt_pk_bf16_f32 v139, v82, v83
    v_pk_max_i16 v136, v136, 0
    v_pk_max_i16 v138, v138, 0
    v_pk_max_i16 v137, v137, 0
    v_pk_max_i16 v139, v139, 0
    v_permlane32_swap_b32 v136, v138
    s_nop 0
    v_permlane32_swap_b32 v137, v139
    s_cmp_lg_u32 s63, 0
    s_cbranch_scc1 L_far_19
    buffer_store_dwordx4 v[136:139], v14, s[32:35], s20 offen
L_near_20:
    s_waitcnt lgkmcnt(6)
    v_mfma_f32_16x16x32_bf16 v[60:63], a[64:67], v[92:95], 0
    ds_read_b64_tr_b16 v[84:85], v28 offset:36864
    buffer_load_dwordx4 v[212:215], v5, s[32:35], s53 offen offset:1024 sc1
    v_mfma_f32_16x16x32_bf16 v[68:71], a[68:71], v[92:95], 0
    ds_read_b64_tr_b16 v[86:87], v28 offset:37888
    s_waitcnt lgkmcnt(6)
    v_mfma_f32_16x16x32_bf16 v[76:79], a[72:75], v[92:95], 0
    ds_read_b64_tr_b16 v[88:89], v29 offset:36864
    buffer_load_dwordx4 v[216:219], v5, s[32:35], s54 offen offset:0 sc1
    v_mfma_f32_16x16x32_bf16 v[64:67], a[64:67], v[96:99], 0
    ds_read_b64_tr_b16 v[90:91], v29 offset:37888
    v_lshlrev_b32 v108, 16, v140
    v_mfma_f32_16x16x32_bf16 v[72:75], a[68:71], v[96:99], 0
    v_and_b32 v109, 0xffff0000, v140
    v_lshlrev_b32 v110, 16, v141
    v_mfma_f32_16x16x32_bf16 v[80:83], a[72:75], v[96:99], 0
    buffer_load_dwordx4 v[220:223], v5, s[32:35], s54 offen offset:1024 sc1
    s_waitcnt lgkmcnt(4)
    v_mfma_f32_16x16x32_bf16 v[60:63], a[76:79], v[248:251], v[60:63]
    ds_read_b64_tr_b16 v[92:93], v28 offset:38912
    v_and_b32 v111, 0xffff0000, v141
    v_mfma_f32_16x16x32_bf16 v[68:71], a[80:83], v[248:251], v[68:71]
    ds_read_b64_tr_b16 v[94:95], v28 offset:39936
    v_lshlrev_b32 v112, 16, v142
    v_mfma_f32_16x16x32_bf16 v[76:79], a[84:87], v[248:251], v[76:79]
    ds_read_b64_tr_b16 v[96:97], v29 offset:38912
    buffer_load_dwordx4 v[224:227], v5, s[32:35], s55 offen offset:0 sc1
    v_mfma_f32_16x16x32_bf16 v[64:67], a[76:79], v[252:255], v[64:67]
    ds_read_b64_tr_b16 v[98:99], v29 offset:39936
    v_and_b32 v113, 0xffff0000, v142
    v_mfma_f32_16x16x32_bf16 v[72:75], a[80:83], v[252:255], v[72:75]
    v_lshlrev_b32 v114, 16, v143
    v_and_b32 v115, 0xffff0000, v143
    v_mfma_f32_16x16x32_bf16 v[80:83], a[84:87], v[252:255], v[80:83]
    buffer_load_dwordx4 v[228:231], v5, s[32:35], s55 offen offset:1024 sc1
    s_waitcnt lgkmcnt(4)
    v_mfma_f32_16x16x32_bf16 v[60:63], a[88:91], v[84:87], v[60:63]
    ds_read_b64_tr_b16 v[248:249], v28 offset:40960
    v_mul_f32 v108, v108, v20
    v_mfma_f32_16x16x32_bf16 v[68:71], a[92:95], v[84:87], v[68:71]
    ds_read_b64_tr_b16 v[250:251], v28 offset:41984
    v_mul_f32 v109, v109, v21
    v_mfma_f32_16x16x32_bf16 v[76:79], a[96:99], v[84:87], v[76:79]
    ds_read_b64_tr_b16 v[252:253], v29 offset:40960
    buffer_load_dwordx4 v[232:235], v5, s[32:35], s56 offen offset:0 sc1
    v_mfma_f32_16x16x32_bf16 v[64:67], a[88:91], v[88:91], v[64:67]
    ds_read_b64_tr_b16 v[254:255], v29 offset:41984
    v_mul_f32 v110, v110, v22
    v_mfma_f32_16x16x32_bf16 v[72:75], a[92:95], v[88:91], v[72:75]
    v_mul_f32 v111, v111, v23
    v_mul_f32 v112, v112, v24
    v_mfma_f32_16x16x32_bf16 v[80:83], a[96:99], v[88:91], v[80:83]
    buffer_load_dwordx4 v[236:239], v5, s[32:35], s56 offen offset:1024 sc1
    s_waitcnt lgkmcnt(4)
    v_mfma_f32_16x16x32_bf16 v[60:63], a[100:103], v[92:95], v[60:63]
    ds_read_b64_tr_b16 v[84:85], v28 offset:43008
    v_mul_f32 v113, v113, v25
    v_mfma_f32_16x16x32_bf16 v[68:71], a[104:107], v[92:95], v[68:71]
    ds_read_b64_tr_b16 v[86:87], v28 offset:44032
    v_mul_f32 v114, v114, v26
    v_mfma_f32_16x16x32_bf16 v[76:79], a[108:111], v[92:95], v[76:79]
    ds_read_b64_tr_b16 v[88:89], v29 offset:43008
    buffer_load_dwordx4 v[240:243], v5, s[32:35], s57 offen offset:0 sc1
    v_mfma_f32_16x16x32_bf16 v[64:67], a[100:103], v[96:99], v[64:67]
    ds_read_b64_tr_b16 v[90:91], v29 offset:44032
    v_mul_f32 v115, v115, v27
    v_mfma_f32_16x16x32_bf16 v[72:75], a[104:107], v[96:99], v[72:75]
    v_add_f32 v140, v108, v109
    v_mul_f32 v141, v108, v108
    v_mfma_f32_16x16x32_bf16 v[80:83], a[108:111], v[96:99], v[80:83]
    buffer_load_dwordx4 v[244:247], v5, s[32:35], s57 offen offset:1024 sc1
    s_waitcnt lgkmcnt(4)
    v_mfma_f32_16x16x32_bf16 v[60:63], a[112:115], v[248:251], v[60:63]
    ds_read_b64_tr_b16 v[92:93], v28 offset:45056
    v_fmac_f32 v141, v109, v109
    v_mfma_f32_16x16x32_bf16 v[68:71], a[116:119], v[248:251], v[68:71]
    ds_read_b64_tr_b16 v[94:95], v28 offset:46080
    v_add_f32 v140, v140, v110
    v_mfma_f32_16x16x32_bf16 v[76:79], a[120:123], v[248:251], v[76:79]
    ds_read_b64_tr_b16 v[96:97], v29 offset:45056
    v_fmac_f32 v141, v110, v110
    v_mfma_f32_16x16x32_bf16 v[64:67], a[112:115], v[252:255], v[64:67]
    ds_read_b64_tr_b16 v[98:99], v29 offset:46080
    v_add_f32 v140, v140, v111
    v_mfma_f32_16x16x32_bf16 v[72:75], a[116:119], v[252:255], v[72:75]
    v_fmac_f32 v141, v111, v111
    v_add_f32 v140, v140, v112
    v_mfma_f32_16x16x32_bf16 v[80:83], a[120:123], v[252:255], v[80:83]
    v_fmac_f32 v141, v112, v112
    s_waitcnt lgkmcnt(4)
    v_mfma_f32_16x16x32_bf16 v[60:63], a[124:127], v[84:87], v[60:63]
    ds_read_b64_tr_b16 v[248:249], v28 offset:47104
    v_add_f32 v140, v140, v113
    v_mfma_f32_16x16x32_bf16 v[68:71], a[128:131], v[84:87], v[68:71]
    ds_read_b64_tr_b16 v[250:251], v28 offset:48128
    v_fmac_f32 v141, v113, v113
    v_mfma_f32_16x16x32_bf16 v[76:79], a[132:135], v[84:87], v[76:79]
    ds_read_b64_tr_b16 v[252:253], v29 offset:47104
    v_add_f32 v140, v140, v114
    v_mfma_f32_16x16x32_bf16 v[64:67], a[124:127], v[88:91], v[64:67]
    ds_read_b64_tr_b16 v[254:255], v29 offset:48128
    v_fmac_f32 v141, v114, v114
    v_mfma_f32_16x16x32_bf16 v[72:75], a[128:131], v[88:91], v[72:75]
    v_add_f32 v140, v140, v115
    v_fmac_f32 v141, v115, v115
    v_mfma_f32_16x16x32_bf16 v[80:83], a[132:135], v[88:91], v[80:83]
    s_nop 0
    v_permlane32_swap_b32 v140, v141
    s_waitcnt lgkmcnt(4)
    v_mfma_f32_16x16x32_bf16 v[60:63], a[136:139], v[92:95], v[60:63]
    ds_read_b64_tr_b16 v[84:85], v28 offset:49152
    v_add_f32 v140, v140, v141
    v_mfma_f32_16x16x32_bf16 v[68:71], a[140:143], v[92:95], v[68:71]
    ds_read_b64_tr_b16 v[86:87], v28 offset:50176
    v_mov_b32 v141, v140
    v_mfma_f32_16x16x32_bf16 v[76:79], a[144:147], v[92:95], v[76:79]
    ds_read_b64_tr_b16 v[88:89], v29 offset:49152
    v_permlane16_swap_b32 v140, v141
    v_mfma_f32_16x16x32_bf16 v[64:67], a[136:139], v[96:99], v[64:67]
    ds_read_b64_tr_b16 v[90:91], v29 offset:50176
    v_add_f32 v140, v140, v141
    v_mfma_f32_16x16x32_bf16 v[72:75], a[140:143], v[96:99], v[72:75]
    v_mov_b32 v141, v140
    s_nop 1
    v_permlane32_swap_b32 v140, v141
    v_mfma_f32_16x16x32_bf16 v[80:83], a[144:147], v[96:99], v[80:83]
    s_mov_b64 exec, 0xffff
    s_cmp_lg_u32 s63, 0
    s_cbranch_scc1 L_far_21
    buffer_store_dwordx2 v[140:141], v19, s[32:35], s23 offen
L_near_22:
    s_mov_b64 exec, -1
    s_add_u32 s23, s23, 4096
    s_waitcnt lgkmcnt(4)
    v_mfma_f32_16x16x32_bf16 v[60:63], a[148:151], v[248:251], v[60:63]
    ds_read_b64_tr_b16 v[92:93], v28 offset:51200
    s_waitcnt vmcnt(10)
    s_mov_b64 exec, 1
    s_cmp_lg_u32 s63, 0
    s_cbranch_scc1 L_far_23
    buffer_store_dword v15, v31, s[32:35], s1 offen offset:0
L_near_24:
    s_mov_b64 exec, -1
    v_mfma_f32_16x16x32_bf16 v[68:71], a[152:155], v[248:251], v[68:71]
    ds_read_b64_tr_b16 v[94:95], v28 offset:52224
    v_mfma_f32_16x16x32_bf16 v[76:79], a[156:159], v[248:251], v[76:79]
    ds_read_b64_tr_b16 v[96:97], v29 offset:51200
    v_mfma_f32_16x16x32_bf16 v[64:67], a[148:151], v[252:255], v[64:67]
    ds_read_b64_tr_b16 v[98:99], v29 offset:52224
    v_mfma_f32_16x16x32_bf16 v[72:75], a[152:155], v[252:255], v[72:75]
    v_mfma_f32_16x16x32_bf16 v[80:83], a[156:159], v[252:255], v[80:83]
    s_waitcnt lgkmcnt(4)
    v_mfma_f32_16x16x32_bf16 v[60:63], a[160:163], v[84:87], v[60:63]
    ds_read_b64_tr_b16 v[248:249], v28 offset:53248
    v_mfma_f32_16x16x32_bf16 v[68:71], a[164:167], v[84:87], v[68:71]
    ds_read_b64_tr_b16 v[250:251], v28 offset:54272
    v_mfma_f32_16x16x32_bf16 v[76:79], a[168:171], v[84:87], v[76:79]
    ds_read_b64_tr_b16 v[252:253], v29 offset:53248
    v_mfma_f32_16x16x32_bf16 v[64:67], a[160:163], v[88:91], v[64:67]
    ds_read_b64_tr_b16 v[254:255], v29 offset:54272
    v_mfma_f32_16x16x32_bf16 v[72:75], a[164:167], v[88:91], v[72:75]
    buffer_load_dword v23, v31, s[32:35], s26 offen offset:0 sc1
    v_mfma_f32_16x16x32_bf16 v[80:83], a[168:171], v[88:91], v[80:83]
    s_waitcnt lgkmcnt(4)
    v_mfma_f32_16x16x32_bf16 v[60:63], a[172:175], v[92:95], v[60:63]
    ds_read_b64_tr_b16 v[84:85], v28 offset:55296
    v_mfma_f32_16x16x32_bf16 v[68:71], a[176:179], v[92:95], v[68:71]
    ds_read_b64_tr_b16 v[86:87], v28 offset:56320
    v_mfma_f32_16x16x32_bf16 v[76:79], a[180:183], v[92:95], v[76:79]
    ds_read_b64_tr_b16 v[88:89], v29 offset:55296
    v_mfma_f32_16x16x32_bf16 v[64:67], a[172:175], v[96:99], v[64:67]
    ds_read_b64_tr_b16 v[90:91], v29 offset:56320
    buffer_load_dwordx4 v[124:127], v3, s[32:35], s25 offen offset:0 sc1
    v_mfma_f32_16x16x32_bf16 v[72:75], a[176:179], v[96:99], v[72:75]
    v_mfma_f32_16x16x32_bf16 v[80:83], a[180:183], v[96:99], v[80:83]
    buffer_load_dwordx4 v[128:131], v3, s[32:35], s25 offen offset:1024 sc1
    s_waitcnt lgkmcnt(4)
    v_mfma_f32_16x16x32_bf16 v[60:63], a[184:187], v[248:251], v[60:63]
    ds_read_b64_tr_b16 v[92:93], v28 offset:57344
    v_mfma_f32_16x16x32_bf16 v[68:71], a[188:191], v[248:251], v[68:71]
    ds_read_b64_tr_b16 v[94:95], v28 offset:58368
    v_mfma_f32_16x16x32_bf16 v[76:79], a[192:195], v[248:251], v[76:79]
    ds_read_b64_tr_b16 v[96:97], v29 offset:57344
    buffer_load_dwordx4 v[132:135], v3, s[32:35], s25 offen offset:2048 sc1
    v_mfma_f32_16x16x32_bf16 v[64:67], a[184:187], v[252:255], v[64:67]
    ds_read_b64_tr_b16 v[98:99], v29 offset:58368
    v_mfma_f32_16x16x32_bf16 v[72:75], a[188:191], v[252:255], v[72:75]
    v_mfma_f32_16x16x32_bf16 v[80:83], a[192:195], v[252:255], v[80:83]
    buffer_load_dwordx4 v[136:139], v3, s[32:35], s25 offen offset:3072 sc1
    s_waitcnt lgkmcnt(4)
    v_mfma_f32_16x16x32_bf16 v[60:63], a[196:199], v[84:87], v[60:63]
    ds_read_b64_tr_b16 v[248:249], v28 offset:59392
    v_mfma_f32_16x16x32_bf16 v[68:71], a[200:203], v[84:87], v[68:71]
    ds_read_b64_tr_b16 v[250:251], v28 offset:60416
    v_mfma_f32_16x16x32_bf16 v[76:79], a[204:207], v[84:87], v[76:79]
    ds_read_b64_tr_b16 v[252:253], v29 offset:59392
    s_waitcnt vmcnt(4)
    v_cmp_ne_u32 vcc, s41, v23
    s_cbranch_vccnz L_retry_25
L_back_26:
    v_mfma_f32_16x16x32_bf16 v[64:67], a[196:199], v[88:91], v[64:67]
    ds_read_b64_tr_b16 v[254:255], v29 offset:60416
    buffer_load_dwordx4 a[64:67], v6, s[32:35], 0 offen offset:0 sc1
    v_mfma_f32_16x16x32_bf16 v[72:75], a[200:203], v[88:91], v[72:75]
    v_mfma_f32_16x16x32_bf16 v[80:83], a[204:207], v[88:91], v[80:83]
    buffer_load_dwordx4 a[68:71], v6, s[32:35], 0 offen offset:2048 sc1
    s_waitcnt lgkmcnt(4)
    v_mfma_f32_16x16x32_bf16 v[60:63], a[208:211], v[92:95], v[60:63]
    ds_read_b64_tr_b16 v[84:85], v28 offset:61440
    v_mfma_f32_16x16x32_bf16 v[68:71], a[212:215], v[92:95], v[68:71]
    ds_read_b64_tr_b16 v[86:87], v28 offset:62464
    v_mfma_f32_16x16x32_bf16 v[76:79], a[216:219], v[92:95], v[76:79]
    ds_read_b64_tr_b16 v[88:89], v29 offset:61440
    buffer_load_dwordx4 a[72:75], v6, s[32:35], s49 offen offset:0 sc1
    v_mfma_f32_16x16x32_bf16 v[64:67], a[208:211], v[96:99], v[64:67]
    ds_read_b64_tr_b16 v[90:91], v29 offset:62464
    v_mfma_f32_16x16x32_bf16 v[72:75], a[212:215], v[96:99], v[72:75]
    v_mfma_f32_16x16x32_bf16 v[80:83], a[216:219], v[96:99], v[80:83]
    buffer_load_dwordx4 a[76:79], v6, s[32:35], s49 offen offset:2048 sc1
    s_waitcnt lgkmcnt(4)
    v_mfma_f32_16x16x32_bf16 v[60:63], a[220:223], v[248:251], v[60:63]
    ds_read_b64_tr_b16 v[92:93], v28 offset:63488
    v_mfma_f32_16x16x32_bf16 v[68:71], a[224:227], v[248:251], v[68:71]
    ds_read_b64_tr_b16 v[94:95], v28 offset:64512
    v_mfma_f32_16x16x32_bf16 v[76:79], a[228:231], v[248:251], v[76:79]
    ds_read_b64_tr_b16 v[96:97], v29 offset:63488
    buffer_load_dwordx4 a[80:83], v6, s[32:35], s50 offen offset:0 sc1
    v_mfma_f32_16x16x32_bf16 v[64:67], a[220:223], v[252:255], v[64:67]
    ds_read_b64_tr_b16 v[98:99], v29 offset:64512
    s_waitcnt vmcnt(5)
    v_max3_u32 v11, v124, v126, v128
    v_max3_u32 v11, v11, v130, v132
    v_max3_u32 v11, v11, v134, v136
    v_max_u32 v11, v11, v138
    v_cmp_eq_u32 vcc, -1, v11
    s_cbranch_vccnz L_retry_27
L_back_28:
    v_mfma_f32_16x16x32_bf16 v[72:75], a[224:227], v[252:255], v[72:75]
    v_add_f32 v124, v124, v132
    v_add_f32 v125, v125, v133
    v_mfma_f32_16x16x32_bf16 v[80:83], a[228:231], v[252:255], v[80:83]
    buffer_load_dwordx4 a[84:87], v6, s[32:35], s50 offen offset:2048 sc1
    s_waitcnt lgkmcnt(4)
    v_mfma_f32_16x16x32_bf16 v[60:63], a[232:235], v[84:87], v[60:63]
    v_add_f32 v126, v126, v134
    v_add_f32 v127, v127, v135
    v_mfma_f32_16x16x32_bf16 v[68:71], a[236:239], v[84:87], v[68:71]
    v_add_f32 v128, v128, v136
    v_add_f32 v129, v129, v137
    v_mfma_f32_16x16x32_bf16 v[76:79], a[240:243], v[84:87], v[76:79]
    buffer_load_dwordx4 a[88:91], v6, s[32:35], s51 offen offset:0 sc1
    v_add_f32 v130, v130, v138
    v_mfma_f32_16x16x32_bf16 v[64:67], a[232:235], v[88:91], v[64:67]
    v_add_f32 v131, v131, v139
    v_add_f32 v124, v124, v128
    v_mfma_f32_16x16x32_bf16 v[72:75], a[236:239], v[88:91], v[72:75]
    v_add_f32 v125, v125, v129
    v_add_f32 v126, v126, v130
    v_mfma_f32_16x16x32_bf16 v[80:83], a[240:243], v[88:91], v[80:83]
    buffer_load_dwordx4 a[92:95], v6, s[32:35], s51 offen offset:2048 sc1
    s_waitcnt lgkmcnt(0)
    v_mfma_f32_16x16x32_bf16 v[60:63], a[244:247], v[92:95], v[60:63]
    v_add_f32 v127, v127, v131
    v_permlane32_swap_b32 v124, v126
    v_mfma_f32_16x16x32_bf16 v[68:71], a[248:251], v[92:95], v[68:71]
    v_permlane32_swap_b32 v125, v127
    v_add_f32 v124, v124, v126
    v_mfma_f32_16x16x32_bf16 v[76:79], a[252:255], v[92:95], v[76:79]
    buffer_load_dwordx4 a[96:99], v6, s[32:35], s52 offen offset:0 sc1
    v_add_f32 v125, v125, v127
    v_mfma_f32_16x16x32_bf16 v[64:67], a[244:247], v[96:99], v[64:67]
    s_nop 0
    v_permlane16_swap_b32 v124, v125
    v_add_f32 v124, v124, v125
    v_mfma_f32_16x16x32_bf16 v[72:75], a[248:251], v[96:99], v[72:75]
    v_mul_f32 v124, 0x3b000000, v124
    v_mov_b32 v125, v124
    v_mfma_f32_16x16x32_bf16 v[80:83], a[252:255], v[96:99], v[80:83]
    buffer_load_dwordx4 a[100:103], v6, s[32:35], s52 offen offset:2048 sc1
    v_permlane16_swap_b32 v124, v125
    v_fma_f32 v125, -v124, v124, v125
    v_max_f32 v125, 0, v125
    v_cvt_pk_bf16_f32 v125, v125, v124
    v_and_b32 v124, 0xffff0000, v125
    v_and_b32 v126, 0xffff0000, v125
    v_lshlrev_b32 v125, 16, v125
    v_add_f32 v125, 0x3727c5ac, v125
    v_cvt_pk_bf16_f32 v125, v125, v125
    v_permlane32_swap_b32 v124, v126
    v_lshlrev_b32 v125, 16, v125
    v_sqrt_f32 v125, v125
    s_nop 0
    v_cvt_pk_bf16_f32 v125, v125, v125
    v_lshlrev_b32 v125, 16, v125
    v_rcp_f32 v127, v125
    v_rcp_f32 v125, v125
    s_nop 1
    v_permlane32_swap_b32 v125, v127
    v_pk_fma_f32 v[60:61], v[36:37], v[124:125], v[60:61] op_sel:[0,0,0] op_sel_hi:[1,0,1] neg_lo:[0,1,0] neg_hi:[0,1,0]
    v_pk_fma_f32 v[62:63], v[38:39], v[124:125], v[62:63] op_sel:[0,0,0] op_sel_hi:[1,0,1] neg_lo:[0,1,0] neg_hi:[0,1,0]
    v_pk_fma_f32 v[64:65], v[36:37], v[126:127], v[64:65] op_sel:[0,0,0] op_sel_hi:[1,0,1] neg_lo:[0,1,0] neg_hi:[0,1,0]
    v_pk_fma_f32 v[66:67], v[38:39], v[126:127], v[66:67] op_sel:[0,0,0] op_sel_hi:[1,0,1] neg_lo:[0,1,0] neg_hi:[0,1,0]
    v_pk_fma_f32 v[60:61], v[60:61], v[124:125], v[48:49] op_sel:[0,1,0] op_sel_hi:[1,1,1]
    v_pk_fma_f32 v[62:63], v[62:63], v[124:125], v[50:51] op_sel:[0,1,0] op_sel_hi:[1,1,1]
    v_pk_fma_f32 v[64:65], v[64:65], v[126:127], v[48:49] op_sel:[0,1,0] op_sel_hi:[1,1,1]
    v_pk_fma_f32 v[66:67], v[66:67], v[126:127], v[50:51] op_sel:[0,1,0] op_sel_hi:[1,1,1]
    v_cvt_pk_bf16_f32 v128, v60, v61
    v_cvt_pk_bf16_f32 v129, v62, v63
    buffer_load_dwordx4 a[104:107], v6, s[32:35], s19 offen offset:0 sc1
    v_cvt_pk_bf16_f32 v130, v64, v65
    v_cvt_pk_bf16_f32 v131, v66, v67
    v_pk_max_i16 v128, v128, 0
    v_pk_max_i16 v130, v130, 0
    v_pk_max_i16 v129, v129, 0
    v_pk_max_i16 v131, v131, 0
    v_pk_fma_f32 v[68:69], v[40:41], v[124:125], v[68:69] op_sel:[0,0,0] op_sel_hi:[1,0,1] neg_lo:[0,1,0] neg_hi:[0,1,0]
    v_pk_fma_f32 v[70:71], v[42:43], v[124:125], v[70:71] op_sel:[0,0,0] op_sel_hi:[1,0,1] neg_lo:[0,1,0] neg_hi:[0,1,0]
    v_permlane32_swap_b32 v128, v130
    v_permlane32_swap_b32 v129, v131
    buffer_load_dwordx4 v[248:251], v5, s[32:35], s18 offen offset:0 sc1
    s_cmp_lg_u32 s63, 0
    s_cbranch_scc1 L_far_29
    buffer_store_dwordx4 v[128:131], v12, s[32:35], s21 offen
L_near_30:
    v_pk_fma_f32 v[72:73], v[40:41], v[126:127], v[72:73] op_sel:[0,0,0] op_sel_hi:[1,0,1] neg_lo:[0,1,0] neg_hi:[0,1,0]
    v_pk_fma_f32 v[74:75], v[42:43], v[126:127], v[74:75] op_sel:[0,0,0] op_sel_hi:[1,0,1] neg_lo:[0,1,0] neg_hi:[0,1,0]
    v_pk_fma_f32 v[68:69], v[68:69], v[124:125], v[52:53] op_sel:[0,1,0] op_sel_hi:[1,1,1]
    v_pk_fma_f32 v[70:71], v[70:71], v[124:125], v[54:55] op_sel:[0,1,0] op_sel_hi:[1,1,1]
    v_pk_fma_f32 v[72:73], v[72:73], v[126:127], v[52:53] op_sel:[0,1,0] op_sel_hi:[1,1,1]
    v_pk_fma_f32 v[74:75], v[74:75], v[126:127], v[54:55] op_sel:[0,1,0] op_sel_hi:[1,1,1]
    v_cvt_pk_bf16_f32 v132, v68, v69
    v_cvt_pk_bf16_f32 v133, v70, v71
    v_cvt_pk_bf16_f32 v134, v72, v73
    buffer_load_dwordx4 v[252:255], v5, s[32:35], s18 offen offset:1024 sc1
    v_cvt_pk_bf16_f32 v135, v74, v75
    v_pk_max_i16 v132, v132, 0
    v_pk_max_i16 v134, v134, 0
    v_pk_max_i16 v133, v133, 0
    v_pk_max_i16 v135, v135, 0
    v_pk_fma_f32 v[76:77], v[44:45], v[124:125], v[76:77] op_sel:[0,0,0] op_sel_hi:[1,0,1] neg_lo:[0,1,0] neg_hi:[0,1,0]
    v_pk_fma_f32 v[78:79], v[46:47], v[124:125], v[78:79] op_sel:[0,0,0] op_sel_hi:[1,0,1] neg_lo:[0,1,0] neg_hi:[0,1,0]
    v_permlane32_swap_b32 v132, v134
    v_permlane32_swap_b32 v133, v135
    s_cmp_lg_u32 s63, 0
    s_cbranch_scc1 L_far_31
    buffer_store_dwordx4 v[132:135], v13, s[32:35], s21 offen
L_near_32:
    buffer_load_dwordx4 a[108:111], v7, s[32:35], 0 offen offset:0 sc1
    v_pk_fma_f32 v[80:81], v[44:45], v[126:127], v[80:81] op_sel:[0,0,0] op_sel_hi:[1,0,1] neg_lo:[0,1,0] neg_hi:[0,1,0]
    v_pk_fma_f32 v[82:83], v[46:47], v[126:127], v[82:83] op_sel:[0,0,0] op_sel_hi:[1,0,1] neg_lo:[0,1,0] neg_hi:[0,1,0]
    v_pk_fma_f32 v[76:77], v[76:77], v[124:125], v[56:57] op_sel:[0,1,0] op_sel_hi:[1,1,1]
    v_pk_fma_f32 v[78:79], v[78:79], v[124:125], v[58:59] op_sel:[0,1,0] op_sel_hi:[1,1,1]
    v_pk_fma_f32 v[80:81], v[80:81], v[126:127], v[56:57] op_sel:[0,1,0] op_sel_hi:[1,1,1]
    v_pk_fma_f32 v[82:83], v[82:83], v[126:127], v[58:59] op_sel:[0,1,0] op_sel_hi:[1,1,1]
    v_cvt_pk_bf16_f32 v136, v76, v77
    v_cvt_pk_bf16_f32 v137, v78, v79
    v_cvt_pk_bf16_f32 v138, v80, v81
    v_cvt_pk_bf16_f32 v139, v82, v83
    buffer_load_dwordx4 a[112:115], v7, s[32:35], 0 offen offset:2048 sc1
    v_pk_max_i16 v136, v136, 0
    v_pk_max_i16 v138, v138, 0
    v_pk_max_i16 v137, v137, 0
    v_pk_max_i16 v139, v139, 0
    v_permlane32_swap_b32 v136, v138
    s_nop 0
    v_permlane32_swap_b32 v137, v139
    s_cmp_lg_u32 s63, 0
    s_cbranch_scc1 L_far_33
    buffer_store_dwordx4 v[136:139], v14, s[32:35], s21 offen
L_near_34:
    s_mul_i32 s66, s3, 6144
    s_add_u32 s66, s66, 65536
    v_add_u32 v16, s66, v3
    s_waitcnt vmcnt(17)
    v_mfma_f32_16x16x32_bf16 v[32:35], a[0:3], a[64:67], 0
    buffer_load_dwordx4 a[116:119], v7, s[32:35], s49 offen offset:0 sc1
    v_mfma_f32_16x16x32_bf16 v[36:39], a[4:7], a[64:67], 0
    buffer_load_dwordx4 a[120:123], v7, s[32:35], s49 offen offset:2048 sc1
    v_mfma_f32_16x16x32_bf16 v[40:43], v[168:171], a[64:67], 0
    v_mfma_f32_16x16x32_bf16 v[44:47], v[172:175], a[64:67], 0
    buffer_load_dwordx4 a[124:127], v7, s[32:35], s50 offen offset:0 sc1
    s_waitcnt vmcnt(19)
    v_mfma_f32_16x16x32_bf16 v[32:35], a[8:11], a[68:71], v[32:35]
    v_mfma_f32_16x16x32_bf16 v[36:39], a[12:15], a[68:71], v[36:39]
    buffer_load_dwordx4 a[128:131], v7, s[32:35], s50 offen offset:2048 sc1
    v_mfma_f32_16x16x32_bf16 v[40:43], v[176:179], a[68:71], v[40:43]
    v_mfma_f32_16x16x32_bf16 v[44:47], v[180:183], a[68:71], v[44:47]
    buffer_load_dwordx4 a[132:135], v7, s[32:35], s51 offen offset:0 sc1
    s_waitcnt vmcnt(20)
    v_mfma_f32_16x16x32_bf16 v[32:35], a[16:19], a[72:75], v[32:35]
    v_mfma_f32_16x16x32_bf16 v[36:39], a[20:23], a[72:75], v[36:39]
    buffer_load_dwordx4 a[136:139], v7, s[32:35], s51 offen offset:2048 sc1
    v_mfma_f32_16x16x32_bf16 v[40:43], v[184:187], a[72:75], v[40:43]
    v_mfma_f32_16x16x32_bf16 v[44:47], v[188:191], a[72:75], v[44:47]
    buffer_load_dwordx4 a[140:143], v7, s[32:35], s52 offen offset:0 sc1
    s_waitcnt vmcnt(21)
    v_mfma_f32_16x16x32_bf16 v[32:35], a[24:27], a[76:79], v[32:35]
    v_mfma_f32_16x16x32_bf16 v[36:39], a[28:31], a[76:79], v[36:39]
    buffer_load_dwordx4 a[144:147], v7, s[32:35], s52 offen offset:2048 sc1
    v_mfma_f32_16x16x32_bf16 v[40:43], v[192:195], a[76:79], v[40:43]
    v_mfma_f32_16x16x32_bf16 v[44:47], v[196:199], a[76:79], v[44:47]
    buffer_load_dwordx4 a[148:151], v7, s[32:35], s19 offen offset:0 sc1
    s_waitcnt vmcnt(22)
    v_mfma_f32_16x16x32_bf16 v[32:35], a[32:35], a[80:83], v[32:35]
    s_waitcnt vmcnt(9)
    s_mov_b64 exec, 1
    s_cmp_lg_u32 s63, 0
    s_cbranch_scc1 L_far_35
    buffer_store_dword v15, v31, s[32:35], s1 offen offset:128
L_near_36:
    s_mov_b64 exec, -1
    v_mfma_f32_16x16x32_bf16 v[36:39], a[36:39], a[80:83], v[36:39]
    v_mfma_f32_16x16x32_bf16 v[40:43], v[200:203], a[80:83], v[40:43]
    v_mfma_f32_16x16x32_bf16 v[44:47], v[204:207], a[80:83], v[44:47]
    v_mfma_f32_16x16x32_bf16 v[32:35], a[40:43], a[84:87], v[32:35]
    v_mfma_f32_16x16x32_bf16 v[36:39], a[44:47], a[84:87], v[36:39]
    v_mfma_f32_16x16x32_bf16 v[40:43], v[208:211], a[84:87], v[40:43]
    v_mfma_f32_16x16x32_bf16 v[44:47], v[212:215], a[84:87], v[44:47]
    v_mfma_f32_16x16x32_bf16 v[32:35], a[48:51], a[88:91], v[32:35]
    v_mfma_f32_16x16x32_bf16 v[36:39], a[52:55], a[88:91], v[36:39]
    v_mfma_f32_16x16x32_bf16 v[40:43], v[216:219], a[88:91], v[40:43]
    v_mfma_f32_16x16x32_bf16 v[44:47], v[220:223], a[88:91], v[44:47]
    v_mfma_f32_16x16x32_bf16 v[32:35], a[56:59], a[92:95], v[32:35]
    v_mfma_f32_16x16x32_bf16 v[36:39], a[60:63], a[92:95], v[36:39]
    v_mfma_f32_16x16x32_bf16 v[40:43], v[224:227], a[92:95], v[40:43]
    v_mfma_f32_16x16x32_bf16 v[44:47], v[228:231], a[92:95], v[44:47]
    v_mfma_f32_16x16x32_bf16 v[32:35], v[144:147], a[96:99], v[32:35]
    v_mfma_f32_16x16x32_bf16 v[36:39], v[148:151], a[96:99], v[36:39]
    v_mfma_f32_16x16x32_bf16 v[40:43], v[232:235], a[96:99], v[40:43]
    buffer_load_dword v23, v31, s[32:35], s26 offen offset:128 sc1
    v_add_u32 v6, s22, v6
    v_add_u32 v7, s22, v7
    v_mfma_f32_16x16x32_bf16 v[44:47], v[236:239], a[96:99], v[44:47]
    v_mfma_f32_16x16x32_bf16 v[32:35], v[152:155], a[100:103], v[32:35]
    v_mfma_f32_16x16x32_bf16 v[36:39], v[156:159], a[100:103], v[36:39]
    v_mfma_f32_16x16x32_bf16 v[40:43], v[240:243], a[100:103], v[40:43]
    v_mfma_f32_16x16x32_bf16 v[44:47], v[244:247], a[100:103], v[44:47]
    v_mfma_f32_16x16x32_bf16 v[32:35], v[160:163], a[104:107], v[32:35]
    v_mfma_f32_16x16x32_bf16 v[36:39], v[164:167], a[104:107], v[36:39]
    v_mfma_f32_16x16x32_bf16 v[40:43], v[248:251], a[104:107], v[40:43]
    v_mfma_f32_16x16x32_bf16 v[44:47], v[252:255], a[104:107], v[44:47]
    v_mfma_f32_16x16x32_bf16 v[48:51], a[0:3], a[108:111], 0
    s_waitcnt vmcnt(0)
    v_cmp_ne_u32 vcc, s41, v23
    s_cbranch_vccnz L_retry_37
L_back_38:
    v_mfma_f32_16x16x32_bf16 v[52:55], a[4:7], a[108:111], 0
    ds_write_b128 v8, v[32:35] offset:0
    buffer_load_dwordx4 a[160:163], v6, s[32:35], 0 offen offset:0 sc1
    v_mfma_f32_16x16x32_bf16 v[48:51], a[8:11], a[112:115], v[48:51]
    ds_write_b128 v8, v[36:39] offset:1024
    buffer_load_dwordx4 a[164:167], v6, s[32:35], 0 offen offset:2048 sc1
    v_mfma_f32_16x16x32_bf16 v[52:55], a[12:15], a[112:115], v[52:55]
    ds_write_b128 v9, v[40:43] offset:0
    v_mfma_f32_16x16x32_bf16 v[48:51], a[16:19], a[116:119], v[48:51]
    ds_write_b128 v9, v[44:47] offset:1024
    buffer_load_dwordx4 a[168:171], v6, s[32:35], s49 offen offset:0 sc1
    v_mfma_f32_16x16x32_bf16 v[52:55], a[20:23], a[116:119], v[52:55]
    v_mfma_f32_16x16x32_bf16 v[48:51], a[24:27], a[120:123], v[48:51]
    buffer_load_dwordx4 a[172:175], v6, s[32:35], s49 offen offset:2048 sc1
    v_mfma_f32_16x16x32_bf16 v[52:55], a[28:31], a[120:123], v[52:55]
    v_mfma_f32_16x16x32_bf16 v[48:51], a[32:35], a[124:127], v[48:51]
    buffer_load_dwordx4 a[176:179], v6, s[32:35], s50 offen offset:0 sc1
    v_mfma_f32_16x16x32_bf16 v[52:55], a[36:39], a[124:127], v[52:55]
    v_mfma_f32_16x16x32_bf16 v[48:51], a[40:43], a[128:131], v[48:51]
    buffer_load_dwordx4 a[180:183], v6, s[32:35], s50 offen offset:2048 sc1
    v_mfma_f32_16x16x32_bf16 v[52:55], a[44:47], a[128:131], v[52:55]
    v_mfma_f32_16x16x32_bf16 v[48:51], a[48:51], a[132:135], v[48:51]
    buffer_load_dwordx4 a[184:187], v6, s[32:35], s51 offen offset:0 sc1
    v_mfma_f32_16x16x32_bf16 v[52:55], a[52:55], a[132:135], v[52:55]
    v_mfma_f32_16x16x32_bf16 v[48:51], a[56:59], a[136:139], v[48:51]
    buffer_load_dwordx4 a[188:191], v6, s[32:35], s51 offen offset:2048 sc1
    v_mfma_f32_16x16x32_bf16 v[52:55], a[60:63], a[136:139], v[52:55]
    v_mfma_f32_16x16x32_bf16 v[48:51], v[144:147], a[140:143], v[48:51]
    buffer_load_dwordx4 a[192:195], v6, s[32:35], s52 offen offset:0 sc1
    v_mfma_f32_16x16x32_bf16 v[52:55], v[148:151], a[140:143], v[52:55]
    v_mfma_f32_16x16x32_bf16 v[48:51], v[152:155], a[144:147], v[48:51]
    buffer_load_dwordx4 a[196:199], v6, s[32:35], s52 offen offset:2048 sc1
    v_mfma_f32_16x16x32_bf16 v[52:55], v[156:159], a[144:147], v[52:55]
    v_mfma_f32_16x16x32_bf16 v[48:51], v[160:163], a[148:151], v[48:51]
    buffer_load_dwordx4 a[200:203], v6, s[32:35], s19 offen offset:0 sc1
    v_mfma_f32_16x16x32_bf16 v[52:55], v[164:167], a[148:151], v[52:55]
    v_mfma_f32_16x16x32_bf16 v[56:59], v[168:171], a[108:111], 0
    buffer_load_dwordx4 a[204:207], v7, s[32:35], 0 offen offset:0 sc1
    v_mfma_f32_16x16x32_bf16 v[60:63], v[172:175], a[108:111], 0
    v_mfma_f32_16x16x32_bf16 v[56:59], v[176:179], a[112:115], v[56:59]
    buffer_load_dwordx4 a[208:211], v7, s[32:35], 0 offen offset:2048 sc1
    v_mfma_f32_16x16x32_bf16 v[60:63], v[180:183], a[112:115], v[60:63]
    ds_write_b128 v10, v[48:51] offset:0
    v_mfma_f32_16x16x32_bf16 v[56:59], v[184:187], a[116:119], v[56:59]
    ds_write_b128 v10, v[52:55] offset:1024
    buffer_load_dwordx4 a[212:215], v7, s[32:35], s49 offen offset:0 sc1
    v_mfma_f32_16x16x32_bf16 v[60:63], v[188:191], a[116:119], v[60:63]
    v_mfma_f32_16x16x32_bf16 v[56:59], v[192:195], a[120:123], v[56:59]
    buffer_load_dwordx4 a[216:219], v7, s[32:35], s49 offen offset:2048 sc1
    v_mfma_f32_16x16x32_bf16 v[60:63], v[196:199], a[120:123], v[60:63]
    v_mfma_f32_16x16x32_bf16 v[56:59], v[200:203], a[124:127], v[56:59]
    s_waitcnt lgkmcnt(0)
    s_barrier
    ds_read_b128 v[64:67], v16 offset:0
    v_mfma_f32_16x16x32_bf16 v[60:63], v[204:207], a[124:127], v[60:63]
    ds_read_b128 v[68:71], v16 offset:1024
    buffer_load_dwordx4 a[220:223], v7, s[32:35], s50 offen offset:0 sc1
    v_mfma_f32_16x16x32_bf16 v[56:59], v[208:211], a[128:131], v[56:59]
    ds_read_b128 v[72:75], v16 offset:2048
    buffer_load_dwordx4 a[224:227], v7, s[32:35], s50 offen offset:2048 sc1
    v_mfma_f32_16x16x32_bf16 v[60:63], v[212:215], a[128:131], v[60:63]
    ds_read_b128 v[76:79], v16 offset:3072
    v_mfma_f32_16x16x32_bf16 v[56:59], v[216:219], a[132:135], v[56:59]
    ds_read_b128 v[80:83], v16 offset:4096
    buffer_load_dwordx4 a[228:231], v7, s[32:35], s51 offen offset:0 sc1
    v_mfma_f32_16x16x32_bf16 v[60:63], v[220:223], a[132:135], v[60:63]
    ds_read_b128 v[84:87], v16 offset:5120
    v_mfma_f32_16x16x32_bf16 v[56:59], v[224:227], a[136:139], v[56:59]
    buffer_load_dwordx4 a[232:235], v7, s[32:35], s51 offen offset:2048 sc1
    v_mfma_f32_16x16x32_bf16 v[60:63], v[228:231], a[136:139], v[60:63]
    v_mfma_f32_16x16x32_bf16 v[56:59], v[232:235], a[140:143], v[56:59]
    buffer_load_dwordx4 a[236:239], v7, s[32:35], s52 offen offset:0 sc1
    v_mfma_f32_16x16x32_bf16 v[60:63], v[236:239], a[140:143], v[60:63]
    s_waitcnt lgkmcnt(0)
    v_add_f32 v64, v64, v72
    v_add_f32 v64, v64, v80
    v_add_f32 v65, v65, v73
    v_add_f32 v65, v65, v81
    v_mfma_f32_16x16x32_bf16 v[56:59], v[240:243], a[144:147], v[56:59]
    v_add_f32 v66, v66, v74
    v_add_f32 v66, v66, v82
    v_add_f32 v67, v67, v75
    v_add_f32 v67, v67, v83
    v_mfma_f32_16x16x32_bf16 v[60:63], v[244:247], a[144:147], v[60:63]
    v_add_f32 v68, v68, v76
    v_add_f32 v68, v68, v84
    v_add_f32 v69, v69, v77
    v_add_f32 v69, v69, v85
    buffer_load_dwordx4 a[240:243], v7, s[32:35], s52 offen offset:2048 sc1
    v_mfma_f32_16x16x32_bf16 v[56:59], v[248:251], a[148:151], v[56:59]
    v_add_f32 v70, v70, v78
    v_add_f32 v70, v70, v86
    v_mfma_f32_16x16x32_bf16 v[60:63], v[252:255], a[148:151], v[60:63]
    v_add_f32 v71, v71, v79
    v_add_f32 v71, v71, v87
    buffer_load_dwordx4 a[244:247], v7, s[32:35], s19 offen offset:0 sc1
    s_lshl2_add_u32 s66, s31, s3
    s_cmp_eq_u32 s66, 0
    s_cbranch_scc1 L_wb0
    buffer_load_dword v22, v31, s[32:35], s34 offen
L_wbd0:
    v_pk_fma_f32 v[100:101], v[64:65], v[116:117], v[100:101]
    v_pk_fma_f32 v[102:103], v[66:67], v[118:119], v[102:103]
    v_pk_fma_f32 v[104:105], v[68:69], v[120:121], v[104:105]
    v_pk_fma_f32 v[106:107], v[70:71], v[122:123], v[106:107]
    v_pk_fma_f32 v[100:101], v[56:57], v[116:117], v[100:101]
    v_pk_fma_f32 v[102:103], v[58:59], v[118:119], v[102:103]
    v_pk_fma_f32 v[104:105], v[60:61], v[120:121], v[104:105]
    v_pk_fma_f32 v[106:107], v[62:63], v[122:123], v[106:107]
    v_cvt_pk_bf16_f32 v140, v100, v101
    v_cvt_pk_bf16_f32 v141, v102, v103
    v_cvt_pk_bf16_f32 v142, v104, v105
    v_cvt_pk_bf16_f32 v143, v106, v107
    global_store_dwordx4 v2, v[140:143], s[28:29] sc1
    v_add_u32 v2, s69, v2
    s_waitcnt vmcnt(23)
    v_mfma_f32_16x16x32_bf16 v[32:35], a[0:3], a[160:163], 0
    v_mfma_f32_16x16x32_bf16 v[36:39], a[4:7], a[160:163], 0
    v_mfma_f32_16x16x32_bf16 v[40:43], v[168:171], a[160:163], 0
    v_mfma_f32_16x16x32_bf16 v[44:47], v[172:175], a[160:163], 0
    s_waitcnt vmcnt(22)
    v_mfma_f32_16x16x32_bf16 v[32:35], a[8:11], a[164:167], v[32:35]
    v_mfma_f32_16x16x32_bf16 v[36:39], a[12:15], a[164:167], v[36:39]
    v_mfma_f32_16x16x32_bf16 v[40:43], v[176:179], a[164:167], v[40:43]
    v_mfma_f32_16x16x32_bf16 v[44:47], v[180:183], a[164:167], v[44:47]
    s_waitcnt vmcnt(21)
    v_mfma_f32_16x16x32_bf16 v[32:35], a[16:19], a[168:171], v[32:35]
    v_mfma_f32_16x16x32_bf16 v[36:39], a[20:23], a[168:171], v[36:39]
    v_mfma_f32_16x16x32_bf16 v[40:43], v[184:187], a[168:171], v[40:43]
    v_mfma_f32_16x16x32_bf16 v[44:47], v[188:191], a[168:171], v[44:47]
    s_waitcnt vmcnt(20)
    v_mfma_f32_16x16x32_bf16 v[32:35], a[24:27], a[172:175], v[32:35]
    v_mfma_f32_16x16x32_bf16 v[36:39], a[28:31], a[172:175], v[36:39]
    v_mfma_f32_16x16x32_bf16 v[40:43], v[192:195], a[172:175], v[40:43]
    v_mfma_f32_16x16x32_bf16 v[44:47], v[196:199], a[172:175], v[44:47]
    s_waitcnt vmcnt(19)
    v_mfma_f32_16x16x32_bf16 v[32:35], a[32:35], a[176:179], v[32:35]
    v_mfma_f32_16x16x32_bf16 v[36:39], a[36:39], a[176:179], v[36:39]
    v_mfma_f32_16x16x32_bf16 v[40:43], v[200:203], a[176:179], v[40:43]
    v_mfma_f32_16x16x32_bf16 v[44:47], v[204:207], a[176:179], v[44:47]
    s_waitcnt vmcnt(18)
    v_mfma_f32_16x16x32_bf16 v[32:35], a[40:43], a[180:183], v[32:35]
    v_mfma_f32_16x16x32_bf16 v[36:39], a[44:47], a[180:183], v[36:39]
    v_mfma_f32_16x16x32_bf16 v[40:43], v[208:211], a[180:183], v[40:43]
    v_mfma_f32_16x16x32_bf16 v[44:47], v[212:215], a[180:183], v[44:47]
    s_waitcnt vmcnt(17)
    v_mfma_f32_16x16x32_bf16 v[32:35], a[48:51], a[184:187], v[32:35]
    v_mfma_f32_16x16x32_bf16 v[36:39], a[52:55], a[184:187], v[36:39]
    v_mfma_f32_16x16x32_bf16 v[40:43], v[216:219], a[184:187], v[40:43]
    v_mfma_f32_16x16x32_bf16 v[44:47], v[220:223], a[184:187], v[44:47]
    s_waitcnt vmcnt(16)
    v_mfma_f32_16x16x32_bf16 v[32:35], a[56:59], a[188:191], v[32:35]
    v_mfma_f32_16x16x32_bf16 v[36:39], a[60:63], a[188:191], v[36:39]
    v_mfma_f32_16x16x32_bf16 v[40:43], v[224:227], a[188:191], v[40:43]
    v_mfma_f32_16x16x32_bf16 v[44:47], v[228:231], a[188:191], v[44:47]
    s_waitcnt vmcnt(15)
    v_mfma_f32_16x16x32_bf16 v[32:35], v[144:147], a[192:195], v[32:35]
    v_mfma_f32_16x16x32_bf16 v[36:39], v[148:151], a[192:195], v[36:39]
    v_mfma_f32_16x16x32_bf16 v[40:43], v[232:235], a[192:195], v[40:43]
    v_mfma_f32_16x16x32_bf16 v[44:47], v[236:239], a[192:195], v[44:47]
    s_waitcnt vmcnt(14)
    v_mfma_f32_16x16x32_bf16 v[32:35], v[152:155], a[196:199], v[32:35]
    v_mfma_f32_16x16x32_bf16 v[36:39], v[156:159], a[196:199], v[36:39]
    v_mfma_f32_16x16x32_bf16 v[40:43], v[240:243], a[196:199], v[40:43]
    v_mfma_f32_16x16x32_bf16 v[44:47], v[244:247], a[196:199], v[44:47]
    s_waitcnt vmcnt(13)
    v_mfma_f32_16x16x32_bf16 v[32:35], v[160:163], a[200:203], v[32:35]
    v_mfma_f32_16x16x32_bf16 v[36:39], v[164:167], a[200:203], v[36:39]
    v_mfma_f32_16x16x32_bf16 v[40:43], v[248:251], a[200:203], v[40:43]
    v_mfma_f32_16x16x32_bf16 v[44:47], v[252:255], a[200:203], v[44:47]
    s_waitcnt vmcnt(12)
    v_mfma_f32_16x16x32_bf16 v[48:51], a[0:3], a[204:207], 0
    v_mfma_f32_16x16x32_bf16 v[52:55], a[4:7], a[204:207], 0
    s_nop 1
    ds_write_b128 v8, v[32:35] offset:24576
    s_waitcnt vmcnt(11)
    v_mfma_f32_16x16x32_bf16 v[48:51], a[8:11], a[208:211], v[48:51]
    ds_write_b128 v8, v[36:39] offset:25600
    v_mfma_f32_16x16x32_bf16 v[52:55], a[12:15], a[208:211], v[52:55]
    ds_write_b128 v9, v[40:43] offset:24576
    s_waitcnt vmcnt(10)
    v_mfma_f32_16x16x32_bf16 v[48:51], a[16:19], a[212:215], v[48:51]
    ds_write_b128 v9, v[44:47] offset:25600
    v_mfma_f32_16x16x32_bf16 v[52:55], a[20:23], a[212:215], v[52:55]
    s_waitcnt vmcnt(9)
    v_mfma_f32_16x16x32_bf16 v[48:51], a[24:27], a[216:219], v[48:51]
    v_mfma_f32_16x16x32_bf16 v[52:55], a[28:31], a[216:219], v[52:55]
    s_waitcnt vmcnt(8)
    v_mfma_f32_16x16x32_bf16 v[48:51], a[32:35], a[220:223], v[48:51]
    v_mfma_f32_16x16x32_bf16 v[52:55], a[36:39], a[220:223], v[52:55]
    s_waitcnt vmcnt(7)
    v_mfma_f32_16x16x32_bf16 v[48:51], a[40:43], a[224:227], v[48:51]
    v_mfma_f32_16x16x32_bf16 v[52:55], a[44:47], a[224:227], v[52:55]
    s_waitcnt vmcnt(6)
    v_mfma_f32_16x16x32_bf16 v[48:51], a[48:51], a[228:231], v[48:51]
    v_mfma_f32_16x16x32_bf16 v[52:55], a[52:55], a[228:231], v[52:55]
    s_waitcnt vmcnt(5)
    v_mfma_f32_16x16x32_bf16 v[48:51], a[56:59], a[232:235], v[48:51]
    v_mfma_f32_16x16x32_bf16 v[52:55], a[60:63], a[232:235], v[52:55]
    s_waitcnt vmcnt(4)
    v_mfma_f32_16x16x32_bf16 v[48:51], v[144:147], a[236:239], v[48:51]
    v_mfma_f32_16x16x32_bf16 v[52:55], v[148:151], a[236:239], v[52:55]
    s_waitcnt vmcnt(3)
    v_mfma_f32_16x16x32_bf16 v[48:51], v[152:155], a[240:243], v[48:51]
    v_mfma_f32_16x16x32_bf16 v[52:55], v[156:159], a[240:243], v[52:55]
    s_waitcnt vmcnt(2)
    v_mfma_f32_16x16x32_bf16 v[48:51], v[160:163], a[244:247], v[48:51]
    v_mfma_f32_16x16x32_bf16 v[52:55], v[164:167], a[244:247], v[52:55]
    v_mfma_f32_16x16x32_bf16 v[56:59], v[168:171], a[204:207], 0
    v_mfma_f32_16x16x32_bf16 v[60:63], v[172:175], a[204:207], 0
    v_mfma_f32_16x16x32_bf16 v[56:59], v[176:179], a[208:211], v[56:59]
    v_mfma_f32_16x16x32_bf16 v[60:63], v[180:183], a[208:211], v[60:63]
    s_nop 2
    ds_write_b128 v10, v[48:51] offset:24576
    v_mfma_f32_16x16x32_bf16 v[56:59], v[184:187], a[212:215], v[56:59]
    ds_write_b128 v10, v[52:55] offset:25600
    v_mfma_f32_16x16x32_bf16 v[60:63], v[188:191], a[212:215], v[60:63]
    v_mfma_f32_16x16x32_bf16 v[56:59], v[192:195], a[216:219], v[56:59]
    v_mfma_f32_16x16x32_bf16 v[60:63], v[196:199], a[216:219], v[60:63]
    v_mfma_f32_16x16x32_bf16 v[56:59], v[200:203], a[220:223], v[56:59]
    s_waitcnt lgkmcnt(0)
    s_barrier
    ds_read_b128 v[64:67], v16 offset:24576
    v_mfma_f32_16x16x32_bf16 v[60:63], v[204:207], a[220:223], v[60:63]
    ds_read_b128 v[68:71], v16 offset:25600
    v_mfma_f32_16x16x32_bf16 v[56:59], v[208:211], a[224:227], v[56:59]
    ds_read_b128 v[72:75], v16 offset:26624
    v_mfma_f32_16x16x32_bf16 v[60:63], v[212:215], a[224:227], v[60:63]
    ds_read_b128 v[76:79], v16 offset:27648
    v_mfma_f32_16x16x32_bf16 v[56:59], v[216:219], a[228:231], v[56:59]
    ds_read_b128 v[80:83], v16 offset:28672
    v_mfma_f32_16x16x32_bf16 v[60:63], v[220:223], a[228:231], v[60:63]
    ds_read_b128 v[84:87], v16 offset:29696
    v_mfma_f32_16x16x32_bf16 v[56:59], v[224:227], a[232:235], v[56:59]
    v_mfma_f32_16x16x32_bf16 v[60:63], v[228:231], a[232:235], v[60:63]
    v_mfma_f32_16x16x32_bf16 v[56:59], v[232:235], a[236:239], v[56:59]
    v_mfma_f32_16x16x32_bf16 v[60:63], v[236:239], a[236:239], v[60:63]
    s_waitcnt lgkmcnt(0)
    v_add_f32 v64, v64, v72
    v_add_f32 v64, v64, v80
    v_add_f32 v65, v65, v73
    v_add_f32 v65, v65, v81
    v_mfma_f32_16x16x32_bf16 v[56:59], v[240:243], a[240:243], v[56:59]
    v_add_f32 v66, v66, v74
    v_add_f32 v66, v66, v82
    v_add_f32 v67, v67, v75
    v_add_f32 v67, v67, v83
    v_mfma_f32_16x16x32_bf16 v[60:63], v[244:247], a[240:243], v[60:63]
    v_add_f32 v68, v68, v76
    v_add_f32 v68, v68, v84
    v_add_f32 v69, v69, v77
    v_add_f32 v69, v69, v85
    v_mfma_f32_16x16x32_bf16 v[56:59], v[248:251], a[244:247], v[56:59]
    v_add_f32 v70, v70, v78
    v_add_f32 v70, v70, v86
    v_mfma_f32_16x16x32_bf16 v[60:63], v[252:255], a[244:247], v[60:63]
    v_add_f32 v71, v71, v79
    v_add_f32 v71, v71, v87
    v_pk_fma_f32 v[108:109], v[64:65], v[116:117], v[108:109]
    v_pk_fma_f32 v[110:111], v[66:67], v[118:119], v[110:111]
    v_pk_fma_f32 v[112:113], v[68:69], v[120:121], v[112:113]
    v_pk_fma_f32 v[114:115], v[70:71], v[122:123], v[114:115]
    v_pk_fma_f32 v[108:109], v[56:57], v[116:117], v[108:109]
    v_pk_fma_f32 v[110:111], v[58:59], v[118:119], v[110:111]
    v_pk_fma_f32 v[112:113], v[60:61], v[120:121], v[112:113]
    v_pk_fma_f32 v[114:115], v[62:63], v[122:123], v[114:115]
    v_cvt_pk_bf16_f32 v140, v108, v109
    v_cvt_pk_bf16_f32 v141, v110, v111
    v_cvt_pk_bf16_f32 v142, v112, v113
    v_cvt_pk_bf16_f32 v143, v114, v115
    global_store_dwordx4 v2, v[140:143], s[28:29] sc1
L_end:
    s_endpgm
L_retry_3:
    s_cmp_eq_u32 s48, 0
    s_cbranch_scc1 L_back_4
    s_sub_u32 s48, s48, 1
    s_nop 1
    buffer_load_dwordx4 v[88:91], v17, s[32:35], 0 offen sc1
    buffer_load_dwordx4 v[92:95], v17, s[32:35], s49 offen sc1
    buffer_load_dwordx4 v[96:99], v17, s[32:35], s50 offen sc1
    buffer_load_dwordx4 v[72:75], v25, s[32:35], s49 offen sc1
    buffer_load_dwordx4 v[76:79], v25, s[32:35], s50 offen sc1
    buffer_load_dwordx4 v[80:83], v25, s[32:35], s51 offen sc1
    buffer_load_dwordx4 v[84:87], v25, s[32:35], s52 offen sc1
    buffer_load_dwordx3 v[100:102], v16, s[32:35], s24 offen sc1
    buffer_load_dword v126, v124, s[32:35], s69 offen sc1
    s_waitcnt vmcnt(0)
    v_xor_b32 v29, s41, v91
    v_bitop3_b32 v29, v29, v95, s41 bitop3:0xf6
    v_bitop3_b32 v29, v29, v99, s41 bitop3:0xf6
    v_bitop3_b32 v29, v29, v75, s41 bitop3:0xf6
    v_bitop3_b32 v29, v29, v79, s41 bitop3:0xf6
    v_bitop3_b32 v29, v29, v83, s41 bitop3:0xf6
    v_bitop3_b32 v29, v29, v87, s41 bitop3:0xf6
    v_bitop3_b32 v29, v29, v102, s41 bitop3:0xf6
    v_bitop3_b32 v29, v29, v126, s41 bitop3:0xf6
    v_cmp_ne_u32 vcc, 0, v29
    s_cbranch_vccnz L_retry_3
    s_branch L_back_4
L_retry_5:
    s_cmp_eq_u32 s48, 0
    s_cbranch_scc1 L_back_6
    s_sub_u32 s48, s48, 1
    s_nop 1
    buffer_load_dwordx4 v[52:55], v26, s[32:35], s56 offen sc1
    s_waitcnt vmcnt(0)
    v_xor_b32 v7, s41, v55
    v_cmp_lt_u32 vcc, 15, v7
    s_cbranch_vccnz L_retry_5
    s_branch L_back_6
L_retry_7:
    s_cmp_eq_u32 s48, 0
    s_cbranch_scc1 L_back_8
    s_sub_u32 s48, s48, 1
    s_nop 1
    buffer_load_dwordx4 v[216:219], v16, s[32:35], 0 offen sc1
    buffer_load_dwordx4 v[220:223], v16, s[32:35], s49 offen sc1
    buffer_load_dwordx4 v[224:227], v16, s[32:35], s50 offen sc1
    buffer_load_dwordx4 v[228:231], v16, s[32:35], s51 offen sc1
    buffer_load_dwordx4 v[232:235], v16, s[32:35], s52 offen sc1
    buffer_load_dwordx4 v[236:239], v16, s[32:35], s53 offen sc1
    buffer_load_dwordx4 v[240:243], v16, s[32:35], s54 offen sc1
    buffer_load_dwordx4 v[244:247], v16, s[32:35], s55 offen sc1
    s_waitcnt vmcnt(0)
    v_max3_u32 v11, v216, v220, v224
    v_max3_u32 v11, v11, v228, v232
    v_max3_u32 v11, v11, v236, v240
    v_max_u32 v11, v11, v244
    v_cmp_eq_u32 vcc, -1, v11
    s_cbranch_vccnz L_retry_7
    s_branch L_back_8
L_retry_11:
    s_cmp_eq_u32 s48, 0
    s_cbranch_scc1 L_back_12
    s_sub_u32 s48, s48, 1
    s_nop 1
    buffer_load_dwordx4 v[216:219], v17, s[32:35], 0 offen sc1
    buffer_load_dwordx4 v[220:223], v17, s[32:35], s49 offen sc1
    buffer_load_dwordx4 v[224:227], v17, s[32:35], s50 offen sc1
    buffer_load_dwordx4 v[228:231], v17, s[32:35], s51 offen sc1
    buffer_load_dwordx4 v[232:235], v17, s[32:35], s52 offen sc1
    buffer_load_dwordx4 v[236:239], v17, s[32:35], s53 offen sc1
    buffer_load_dwordx4 v[240:243], v17, s[32:35], s54 offen sc1
    buffer_load_dwordx4 v[244:247], v17, s[32:35], s55 offen sc1
    s_waitcnt vmcnt(0)
    v_max3_u32 v11, v216, v220, v224
    v_max3_u32 v11, v11, v228, v232
    v_max3_u32 v11, v11, v236, v240
    v_max_u32 v11, v11, v244
    v_cmp_eq_u32 vcc, -1, v11
    s_cbranch_vccnz L_retry_11
    s_branch L_back_12
L_retry_13:
    s_cmp_eq_u32 s48, 0
    s_cbranch_scc1 L_back_14
    s_sub_u32 s48, s48, 1
    s_nop 1
    buffer_load_dwordx4 v[124:127], v3, s[32:35], s24 offen offset:0 sc1
    buffer_load_dwordx4 v[128:131], v3, s[32:35], s24 offen offset:1024 sc1
    buffer_load_dwordx4 v[132:135], v3, s[32:35], s24 offen offset:2048 sc1
    buffer_load_dwordx4 v[136:139], v3, s[32:35], s24 offen offset:3072 sc1
    s_waitcnt vmcnt(0)
    v_max3_u32 v11, v124, v126, v128
    v_max3_u32 v11, v11, v130, v132
    v_max3_u32 v11, v11, v134, v136
    v_max_u32 v11, v11, v138
    v_cmp_eq_u32 vcc, -1, v11
    s_cbranch_vccnz L_retry_13
    s_branch L_back_14
L_retry_25:
    s_cmp_eq_u32 s48, 0
    s_cbranch_scc1 L_back_26
    s_sub_u32 s48, s48, 1
    s_nop 1
    buffer_load_dword v23, v31, s[32:35], s26 offen offset:0 sc1
    s_waitcnt vmcnt(0)
    v_cmp_ne_u32 vcc, s41, v23
    s_cbranch_vccnz L_retry_25
    s_branch L_back_26
L_retry_27:
    s_cmp_eq_u32 s48, 0
    s_cbranch_scc1 L_back_28
    s_sub_u32 s48, s48, 1
    s_nop 1
    buffer_load_dwordx4 v[124:127], v3, s[32:35], s25 offen offset:0 sc1
    buffer_load_dwordx4 v[128:131], v3, s[32:35], s25 offen offset:1024 sc1
    buffer_load_dwordx4 v[132:135], v3, s[32:35], s25 offen offset:2048 sc1
    buffer_load_dwordx4 v[136:139], v3, s[32:35], s25 offen offset:3072 sc1
    s_waitcnt vmcnt(0)
    v_max3_u32 v11, v124, v126, v128
    v_max3_u32 v11, v11, v130, v132
    v_max3_u32 v11, v11, v134, v136
    v_max_u32 v11, v11, v138
    v_cmp_eq_u32 vcc, -1, v11
    s_cbranch_vccnz L_retry_27
    s_branch L_back_28
L_retry_37:
    s_cmp_eq_u32 s48, 0
    s_cbranch_scc1 L_back_38
    s_sub_u32 s48, s48, 1
    s_nop 1
    buffer_load_dword v23, v31, s[32:35], s26 offen offset:128 sc1
    s_waitcnt vmcnt(0)
    v_cmp_ne_u32 vcc, s41, v23
    s_cbranch_vccnz L_retry_37
    s_branch L_back_38
L_far_1:
    buffer_store_dwordx4 v[48:51], v99, s[32:35], 0 offen sc1
    buffer_store_dwordx4 v[52:55], v99, s[32:35], s49 offen sc1
    buffer_store_dwordx4 v[56:59], v99, s[32:35], s50 offen sc1
    s_nop 0
    s_branch L_near_2
L_far_9:
    buffer_store_dwordx2 v[140:141], v19, s[32:35], s23 offen sc1
    s_nop 0
    s_branch L_near_10
L_far_15:
    buffer_store_dwordx4 v[128:131], v12, s[32:35], s20 offen sc1
    s_nop 0
    s_branch L_near_16
L_far_17:
    buffer_store_dwordx4 v[132:135], v13, s[32:35], s20 offen sc1
    s_nop 0
    s_branch L_near_18
L_far_19:
    buffer_store_dwordx4 v[136:139], v14, s[32:35], s20 offen sc1
    s_nop 0
    s_branch L_near_20
L_far_21:
    buffer_store_dwordx2 v[140:141], v19, s[32:35], s23 offen sc1
    s_nop 0
    s_branch L_near_22
L_far_23:
    buffer_store_dword v15, v31, s[32:35], s1 offen offset:0 sc1
    s_nop 0
    s_branch L_near_24
L_far_29:
    buffer_store_dwordx4 v[128:131], v12, s[32:35], s21 offen sc1
    s_nop 0
    s_branch L_near_30
L_far_31:
    buffer_store_dwordx4 v[132:135], v13, s[32:35], s21 offen sc1
    s_nop 0
    s_branch L_near_32
L_far_33:
    buffer_store_dwordx4 v[136:139], v14, s[32:35], s21 offen sc1
    s_nop 0
    s_branch L_near_34
L_far_35:
    buffer_store_dword v15, v31, s[32:35], s1 offen offset:128 sc1
    s_nop 0
    s_branch L_near_36
L_wb0:
    buffer_wbl2 sc1
    s_nop 0
    s_branch L_wbd0
L_gather:
    v_and_b32 v28, 15, v0
    v_lshlrev_b32 v28, 14, v28
    v_and_b32 v29, 48, v0
    v_lshl_add_u32 v28, v29, 8, v28
    s_lshl_b32 s0, s3, 18
    s_lshl2_add_u32 s0, s40, s0
    v_add_u32 v28, s0, v28
    v_add_u32 v29, 0x100000, v28
    global_load_dword v88, v28, s[4:5] offset:0
    global_load_dword v89, v28, s[4:5] offset:1024
    global_load_dword v90, v28, s[4:5] offset:2048
    global_load_dword v92, v28, s[4:5] offset:3072
    global_load_dword v93, v29, s[4:5] offset:0
    global_load_dword v94, v29, s[4:5] offset:1024
    global_load_dword v96, v29, s[4:5] offset:2048
    global_load_dword v97, v29, s[4:5] offset:3072
    s_waitcnt vmcnt(0)
    s_branch L_gathered
.p2align 6
.type L_tab,@object
L_tab:
.short 16896, 17424, 17952, 18480, 24288, 24288, 24288, 24816, 19008, 19536, 20064, 20592, 24816, 24816, 25344, 25344, 21648, 21120, 22176, 22704, 25872, 25344, 25872, 26400, 22704, 22704, 23232, 23760, 26400, 26400, 26928, 26928, 27456, 27456, 27456, 27456, 29568, 29568, 29568, 29568, 27456, 27984, 27984, 27984, 29568, 30096, 30096, 30096, 28512, 27984, 28512, 28512, 30624, 30096, 30624, 30624, 28512, 29040, 29040, 29040, 30624, 31152, 31152, 31152
L_tabend:
.section .rodata,"a"
.p2align 6
.amdhsa_kernel adaLN_cond__ssm_conv_s4d__dense_activation_relu__prompt_kernel
  .amdhsa_next_free_vgpr 512
  .amdhsa_next_free_sgpr 102
  .amdhsa_accum_offset 256
  .amdhsa_group_segment_fixed_size 0
  .amdhsa_kernarg_size 120
  .amdhsa_user_sgpr_count 2
  .amdhsa_user_sgpr_kernarg_segment_ptr 1
  .amdhsa_system_sgpr_workgroup_id_x 1
.end_amdhsa_kernel
```
